```python
import torch

def _softmax(x, axis=-1):
    return torch.softmax(x, dim=axis)
def _gelu(x):
    return torch.nn.functional.gelu(x, approximate="tanh")
def _silu(x):
    return torch.nn.functional.silu(x)
def _sigmoid(x):
    return torch.sigmoid(x)
def _layernorm(x, axis=-1, eps=1e-5):
    m = x.mean(dim=axis, keepdim=True)
    v = x.var(dim=axis, keepdim=True, unbiased=False)
    return (x - m) / torch.sqrt(v + eps)
def _scatter_add(tgt, idx, src, axis=0):
    return tgt.clone().index_add_(axis, idx, src)
def _segment_sum(src, seg, n):
    out = torch.zeros((n,) + src.shape[1:], dtype=src.dtype)
    return out.index_add_(0, seg, src)
def _pad(x, pw):
    flat = tuple(v for pair in reversed(pw) for v in pair)
    return torch.nn.functional.pad(x, flat)

kernel_name = 'recurrent_scan__ssm_conv_s5__glu_gated_glu__prompt'

def setup_inputs():

    _w = (lambda a: (lambda t: t.to(torch.bfloat16) if t.is_floating_point() else t)(torch.as_tensor(a)))
    def _A_setup():
        B, S, D = 1, 2048, 512
        P = D
        Lambda_re = -0.5 * (lambda _x: torch.exp(torch.as_tensor(_x)))((lambda *s: torch.randn(*s, dtype=torch.bfloat16) * 0.2)(P))
        Lambda_im = (lambda *s: torch.randn(*s, dtype=torch.bfloat16) * 0.4)(P) * 1.0
        B_re = (lambda *s: torch.randn(*s, dtype=torch.bfloat16) * 0.2)(P, D) * (D ** -0.5)
        B_im = (lambda *s: torch.randn(*s, dtype=torch.bfloat16) * 0.2)(P, D) * (D ** -0.5)
        C_re = (lambda *s: torch.randn(*s, dtype=torch.bfloat16) * 0.2)(D, P) * (P ** -0.5)
        C_im = (lambda *s: torch.randn(*s, dtype=torch.bfloat16) * 0.2)(D, P) * (P ** -0.5)
        log_dt = (lambda *s: torch.randn(*s, dtype=torch.bfloat16) * 0.2)(P) * 0.3 - 2.0
        Dskip = (lambda *s: torch.randn(*s, dtype=torch.bfloat16) * 0.05)(D)
        return {
            "x": _w((lambda *s: torch.randn(*s, dtype=torch.bfloat16) * 0.05)(B, S, D)),
            "Lambda_re": _w(Lambda_re),
            "Lambda_im": _w(Lambda_im),
            "B_re": _w(B_re),
            "B_im": _w(B_im),
            "C_re": _w(C_re),
            "C_im": _w(C_im),
            "log_dt": _w(log_dt),
            "Dskip": _w(Dskip),
        }
    _A_in = _A_setup()

    def _B_setup():
        B, S, D, F = 1, 2048, 512, 1792
        return {
            "x": _w((lambda *s: torch.randn(*s, dtype=torch.bfloat16) * 0.05)(B, S, D)),
            "w_gate": _w((lambda *s: torch.randn(*s, dtype=torch.bfloat16) * 0.05)(D, F)),
            "w_up": _w((lambda *s: torch.randn(*s, dtype=torch.bfloat16) * 0.05)(D, F)),
            "w_down": _w((lambda *s: torch.randn(*s, dtype=torch.bfloat16) * 0.05)(F, D)),
        }
    _B_in = _B_setup()

    return {
        "A_x": _A_in["x"],
        "A_Lambda_re": _A_in["Lambda_re"],
        "A_Lambda_im": _A_in["Lambda_im"],
        "A_B_re": _A_in["B_re"],
        "A_B_im": _A_in["B_im"],
        "A_C_re": _A_in["C_re"],
        "A_C_im": _A_in["C_im"],
        "A_log_dt": _A_in["log_dt"],
        "A_Dskip": _A_in["Dskip"],
        "B_x": _B_in["x"],
        "B_w_gate": _B_in["w_gate"],
        "B_w_up": _B_in["w_up"],
        "B_w_down": _B_in["w_down"],
    }

def reference(A_x, A_Lambda_re, A_Lambda_im, A_B_re, A_B_im, A_C_re, A_C_im, A_log_dt, A_Dskip, B_x, B_w_gate, B_w_up, B_w_down):
    def _A_ref(x, Lambda_re, Lambda_im, B_re, B_im, C_re, C_im, log_dt, Dskip):
        Bsz, L, H = x.shape
        Lam = Lambda_re + 1j * Lambda_im
        Bmat = B_re + 1j * B_im
        Cmat = C_re + 1j * C_im
        dt = torch.exp(log_dt)
        Lam_bar = torch.exp(dt * Lam)
        B_bar = ((Lam_bar - 1.0) / Lam)[:, None] * Bmat
        Bu = torch.einsum("bld,pd->blp", x + 0j, B_bar)
        h = torch.zeros_like(Bu[:, 0, :])
        hs = []
        for t in range(L):
            h = Lam_bar[None, :] * h + Bu[:, t, :]
            hs.append(h)
        hseq = torch.stack(hs, 1)
        y = 2.0 * torch.einsum("blp,dp->bld", hseq, Cmat).real + x * Dskip[None, None, :]
        return y

    def _B_ref(x, w_gate, w_up, w_down):
        g = torch.einsum("bsd,df->bsf", x, w_gate)
        u = torch.einsum("bsd,df->bsf", x, w_up)
        h = _sigmoid(g) * u
        return torch.einsum("bsf,fd->bsd", h, w_down)

    x = A_x
    xn = _layernorm(x, axis=-1)
    s = _A_ref(xn, A_Lambda_re, A_Lambda_im, A_B_re, A_B_im, A_C_re, A_C_im, A_log_dt, A_Dskip)
    g = _silu(_B_ref(xn, B_w_gate, B_w_up, B_w_down))
    return x + s * g
```

```asm
; @launch kernel=ssm_k0_kernel grid=(256,1,1) block=(256,1,1) lds=32768
; @launch kernel=ssm_k1_kernel grid=(256,1,1) block=(512,1,1) lds=151552
; @launch kernel=ssm_k2_kernel grid=(256,1,1) block=(256,1,1) lds=131072
.amdgcn_target "amdgcn-amd-amdhsa--gfx950"
.text
.globl ssm_k0_kernel
.p2align 8
.type ssm_k0_kernel,@function
ssm_k0_kernel:
    s_cmp_ge_u32 s2, 256
    s_cbranch_scc1 K0_END
    s_load_dwordx16 s[64:79], s[0:1], 0
    s_load_dwordx16 s[80:95], s[0:1], 64
    v_and_b32 v1, 63, v0
    v_lshrrev_b32 v2, 6, v0
    s_nop 0
    v_readfirstlane_b32 s42, v2
    s_waitcnt lgkmcnt(0)
    s_mov_b32 s8, s94
    s_and_b32 s9, s95, 0xffff
    s_mov_b32 s10, 33554432
    s_mov_b32 s11, 0x00020000
    s_cmp_ge_u32 s2, 256
    s_cbranch_scc1 K0_NOZERO
    s_cmp_eq_u32 s42, 0
    s_cbranch_scc0 K0_NOZERO
    s_lshl_b32 s3, s2, 8
    s_add_u32 s3, s3, 22085632
    v_lshlrev_b32 v3, 2, v1
    v_mov_b32 v4, 0
    buffer_store_dword v4, v3, s[8:11], s3 offen
    s_cmp_ge_u32 s2, 32
    s_cbranch_scc1 K0_NOZERO
    s_add_u32 s3, s3, 0x10000
    buffer_store_dword v4, v3, s[8:11], s3 offen
K0_NOZERO:
    s_nop 1
    s_cmp_ge_u32 s2, 128
    s_cbranch_scc1 K0_NOTLN
    s_mov_b32 s12, s64
    s_and_b32 s13, s65, 0xffff
    s_mov_b32 s14, 2097152
    s_mov_b32 s15, 0x00020000
    s_lshl_b32 s3, s2, 4
    s_lshl_b32 s4, s42, 2
    s_add_u32 s3, s3, s4
    s_lshl_b32 s4, s3, 10
    v_lshlrev_b32 v3, 4, v1
    v_add_u32 v3, s4, v3
    buffer_load_dwordx4 v[16:19], v3, s[12:15], 0 offen offset:0
    buffer_load_dwordx4 v[20:23], v3, s[12:15], 0 offen offset:1024
    buffer_load_dwordx4 v[24:27], v3, s[12:15], 0 offen offset:2048
    buffer_load_dwordx4 v[28:31], v3, s[12:15], 0 offen offset:3072
    v_mov_b32 v4, 0x3f803f80
    v_mov_b32 v5, 0x00003f80
    v_mov_b32 v6, 0x3f800000
    s_lshr_b32 s5, s3, 5
    s_lshl_b32 s5, s5, 15
    s_and_b32 s6, s3, 31
    s_lshl_b32 s6, s6, 4
    s_add_u32 s5, s5, s6
    v_lshrrev_b32 v7, 1, v1
    v_lshlrev_b32 v7, 10, v7
    v_and_b32 v8, 1, v1
    v_lshl_add_u32 v7, v8, 9, v7
    v_add_u32 v7, s5, v7
    s_waitcnt vmcnt(3)
    v_dot2_f32_bf16 v32, v16, v4, 0
    v_dot2_f32_bf16 v33, v16, v16, 0
    v_dot2_f32_bf16 v32, v17, v4, v32
    v_dot2_f32_bf16 v33, v17, v17, v33
    v_dot2_f32_bf16 v32, v18, v4, v32
    v_dot2_f32_bf16 v33, v18, v18, v33
    v_dot2_f32_bf16 v32, v19, v4, v32
    v_dot2_f32_bf16 v33, v19, v19, v33
    s_waitcnt vmcnt(2)
    v_dot2_f32_bf16 v34, v20, v4, 0
    v_dot2_f32_bf16 v35, v20, v20, 0
    v_dot2_f32_bf16 v34, v21, v4, v34
    v_dot2_f32_bf16 v35, v21, v21, v35
    v_dot2_f32_bf16 v34, v22, v4, v34
    v_dot2_f32_bf16 v35, v22, v22, v35
    v_dot2_f32_bf16 v34, v23, v4, v34
    v_dot2_f32_bf16 v35, v23, v23, v35
    s_waitcnt vmcnt(1)
    v_dot2_f32_bf16 v36, v24, v4, 0
    v_dot2_f32_bf16 v37, v24, v24, 0
    v_dot2_f32_bf16 v36, v25, v4, v36
    v_dot2_f32_bf16 v37, v25, v25, v37
    v_dot2_f32_bf16 v36, v26, v4, v36
    v_dot2_f32_bf16 v37, v26, v26, v37
    v_dot2_f32_bf16 v36, v27, v4, v36
    v_dot2_f32_bf16 v37, v27, v27, v37
    s_waitcnt vmcnt(0)
    v_dot2_f32_bf16 v38, v28, v4, 0
    v_dot2_f32_bf16 v39, v28, v28, 0
    v_dot2_f32_bf16 v38, v29, v4, v38
    v_dot2_f32_bf16 v39, v29, v29, v39
    v_dot2_f32_bf16 v38, v30, v4, v38
    v_dot2_f32_bf16 v39, v30, v30, v39
    v_dot2_f32_bf16 v38, v31, v4, v38
    v_dot2_f32_bf16 v39, v31, v31, v39
    v_add_f32_dpp v32, v32, v32 quad_perm:[1,0,3,2] row_mask:0xf bank_mask:0xf
    v_add_f32_dpp v33, v33, v33 quad_perm:[1,0,3,2] row_mask:0xf bank_mask:0xf
    v_add_f32_dpp v34, v34, v34 quad_perm:[1,0,3,2] row_mask:0xf bank_mask:0xf
    v_add_f32_dpp v35, v35, v35 quad_perm:[1,0,3,2] row_mask:0xf bank_mask:0xf
    v_add_f32_dpp v36, v36, v36 quad_perm:[1,0,3,2] row_mask:0xf bank_mask:0xf
    v_add_f32_dpp v37, v37, v37 quad_perm:[1,0,3,2] row_mask:0xf bank_mask:0xf
    v_add_f32_dpp v38, v38, v38 quad_perm:[1,0,3,2] row_mask:0xf bank_mask:0xf
    v_add_f32_dpp v39, v39, v39 quad_perm:[1,0,3,2] row_mask:0xf bank_mask:0xf
    v_add_f32_dpp v32, v32, v32 quad_perm:[2,3,0,1] row_mask:0xf bank_mask:0xf
    v_add_f32_dpp v33, v33, v33 quad_perm:[2,3,0,1] row_mask:0xf bank_mask:0xf
    v_add_f32_dpp v34, v34, v34 quad_perm:[2,3,0,1] row_mask:0xf bank_mask:0xf
    v_add_f32_dpp v35, v35, v35 quad_perm:[2,3,0,1] row_mask:0xf bank_mask:0xf
    v_add_f32_dpp v36, v36, v36 quad_perm:[2,3,0,1] row_mask:0xf bank_mask:0xf
    v_add_f32_dpp v37, v37, v37 quad_perm:[2,3,0,1] row_mask:0xf bank_mask:0xf
    v_add_f32_dpp v38, v38, v38 quad_perm:[2,3,0,1] row_mask:0xf bank_mask:0xf
    v_add_f32_dpp v39, v39, v39 quad_perm:[2,3,0,1] row_mask:0xf bank_mask:0xf
    v_add_f32_dpp v32, v32, v32 row_half_mirror row_mask:0xf bank_mask:0xf
    v_add_f32_dpp v33, v33, v33 row_half_mirror row_mask:0xf bank_mask:0xf
    v_add_f32_dpp v34, v34, v34 row_half_mirror row_mask:0xf bank_mask:0xf
    v_add_f32_dpp v35, v35, v35 row_half_mirror row_mask:0xf bank_mask:0xf
    v_add_f32_dpp v36, v36, v36 row_half_mirror row_mask:0xf bank_mask:0xf
    v_add_f32_dpp v37, v37, v37 row_half_mirror row_mask:0xf bank_mask:0xf
    v_add_f32_dpp v38, v38, v38 row_half_mirror row_mask:0xf bank_mask:0xf
    v_add_f32_dpp v39, v39, v39 row_half_mirror row_mask:0xf bank_mask:0xf
    v_add_f32_dpp v32, v32, v32 row_mirror row_mask:0xf bank_mask:0xf
    v_add_f32_dpp v33, v33, v33 row_mirror row_mask:0xf bank_mask:0xf
    v_add_f32_dpp v34, v34, v34 row_mirror row_mask:0xf bank_mask:0xf
    v_add_f32_dpp v35, v35, v35 row_mirror row_mask:0xf bank_mask:0xf
    v_add_f32_dpp v36, v36, v36 row_mirror row_mask:0xf bank_mask:0xf
    v_add_f32_dpp v37, v37, v37 row_mirror row_mask:0xf bank_mask:0xf
    v_add_f32_dpp v38, v38, v38 row_mirror row_mask:0xf bank_mask:0xf
    v_add_f32_dpp v39, v39, v39 row_mirror row_mask:0xf bank_mask:0xf
    v_mov_b32 v40, v32
    v_mov_b32 v41, v33
    v_mov_b32 v42, v34
    v_mov_b32 v43, v35
    v_mov_b32 v44, v36
    v_mov_b32 v45, v37
    v_mov_b32 v46, v38
    v_mov_b32 v47, v39
    v_permlane16_swap_b32 v32, v40
    v_permlane16_swap_b32 v33, v41
    v_permlane16_swap_b32 v34, v42
    v_permlane16_swap_b32 v35, v43
    v_permlane16_swap_b32 v36, v44
    v_permlane16_swap_b32 v37, v45
    v_permlane16_swap_b32 v38, v46
    v_permlane16_swap_b32 v39, v47
    v_add_f32 v32, v32, v40
    v_add_f32 v33, v33, v41
    v_add_f32 v34, v34, v42
    v_add_f32 v35, v35, v43
    v_add_f32 v36, v36, v44
    v_add_f32 v37, v37, v45
    v_add_f32 v38, v38, v46
    v_add_f32 v39, v39, v47
    v_mov_b32 v40, v32
    v_mov_b32 v41, v33
    v_mov_b32 v42, v34
    v_mov_b32 v43, v35
    v_mov_b32 v44, v36
    v_mov_b32 v45, v37
    v_mov_b32 v46, v38
    v_mov_b32 v47, v39
    v_permlane32_swap_b32 v32, v40
    v_permlane32_swap_b32 v33, v41
    v_permlane32_swap_b32 v34, v42
    v_permlane32_swap_b32 v35, v43
    v_permlane32_swap_b32 v36, v44
    v_permlane32_swap_b32 v37, v45
    v_permlane32_swap_b32 v38, v46
    v_permlane32_swap_b32 v39, v47
    v_add_f32 v32, v32, v40
    v_add_f32 v33, v33, v41
    v_add_f32 v34, v34, v42
    v_add_f32 v35, v35, v43
    v_add_f32 v36, v36, v44
    v_add_f32 v37, v37, v45
    v_add_f32 v38, v38, v46
    v_add_f32 v39, v39, v47
    v_mul_f32 v32, 0x3b000000, v32
    v_mul_f32 v33, 0x3b000000, v33
    v_fma_f32 v33, -v32, v32, v33
    v_max_f32 v33, 0, v33
    v_cvt_pk_bf16_f32 v32, v32, v33
    v_lshlrev_b32 v56, 16, v32
    v_and_b32 v33, 0xffff0000, v32
    v_add_f32 v33, 0x3727c5ac, v33
    v_cvt_pk_bf16_f32 v33, v33, v33
    v_lshlrev_b32 v33, 16, v33
    v_sqrt_f32 v33, v33
    s_nop 0
    v_cvt_pk_bf16_f32 v33, v33, v33
    v_lshlrev_b32 v33, 16, v33
    v_rcp_f32 v52, v33
    s_nop 0
    v_fma_f32 v32, -v33, v52, 1.0
    v_fma_f32 v52, v32, v52, v52
    v_sub_f32 v48, 0, v56
    v_mov_b32 v57, v52
    v_mul_f32 v34, 0x3b000000, v34
    v_mul_f32 v35, 0x3b000000, v35
    v_fma_f32 v35, -v34, v34, v35
    v_max_f32 v35, 0, v35
    v_cvt_pk_bf16_f32 v34, v34, v35
    v_lshlrev_b32 v58, 16, v34
    v_and_b32 v35, 0xffff0000, v34
    v_add_f32 v35, 0x3727c5ac, v35
    v_cvt_pk_bf16_f32 v35, v35, v35
    v_lshlrev_b32 v35, 16, v35
    v_sqrt_f32 v35, v35
    s_nop 0
    v_cvt_pk_bf16_f32 v35, v35, v35
    v_lshlrev_b32 v35, 16, v35
    v_rcp_f32 v53, v35
    s_nop 0
    v_fma_f32 v34, -v35, v53, 1.0
    v_fma_f32 v53, v34, v53, v53
    v_sub_f32 v49, 0, v58
    v_mov_b32 v59, v53
    v_mul_f32 v36, 0x3b000000, v36
    v_mul_f32 v37, 0x3b000000, v37
    v_fma_f32 v37, -v36, v36, v37
    v_max_f32 v37, 0, v37
    v_cvt_pk_bf16_f32 v36, v36, v37
    v_lshlrev_b32 v60, 16, v36
    v_and_b32 v37, 0xffff0000, v36
    v_add_f32 v37, 0x3727c5ac, v37
    v_cvt_pk_bf16_f32 v37, v37, v37
    v_lshlrev_b32 v37, 16, v37
    v_sqrt_f32 v37, v37
    s_nop 0
    v_cvt_pk_bf16_f32 v37, v37, v37
    v_lshlrev_b32 v37, 16, v37
    v_rcp_f32 v54, v37
    s_nop 0
    v_fma_f32 v36, -v37, v54, 1.0
    v_fma_f32 v54, v36, v54, v54
    v_sub_f32 v50, 0, v60
    v_mov_b32 v61, v54
    v_mul_f32 v38, 0x3b000000, v38
    v_mul_f32 v39, 0x3b000000, v39
    v_fma_f32 v39, -v38, v38, v39
    v_max_f32 v39, 0, v39
    v_cvt_pk_bf16_f32 v38, v38, v39
    v_lshlrev_b32 v62, 16, v38
    v_and_b32 v39, 0xffff0000, v38
    v_add_f32 v39, 0x3727c5ac, v39
    v_cvt_pk_bf16_f32 v39, v39, v39
    v_lshlrev_b32 v39, 16, v39
    v_sqrt_f32 v39, v39
    s_nop 0
    v_cvt_pk_bf16_f32 v39, v39, v39
    v_lshlrev_b32 v39, 16, v39
    v_rcp_f32 v55, v39
    s_nop 0
    v_fma_f32 v38, -v39, v55, 1.0
    v_fma_f32 v55, v38, v55, v55
    v_sub_f32 v51, 0, v62
    v_mov_b32 v63, v55
    v_dot2_f32_bf16 v64, v16, v5, v48
    v_dot2_f32_bf16 v65, v16, v6, v48
    v_dot2_f32_bf16 v66, v17, v5, v48
    v_dot2_f32_bf16 v67, v17, v6, v48
    v_dot2_f32_bf16 v68, v18, v5, v48
    v_dot2_f32_bf16 v69, v18, v6, v48
    v_dot2_f32_bf16 v70, v19, v5, v48
    v_dot2_f32_bf16 v71, v19, v6, v48
    v_cvt_pk_bf16_f32 v16, v64, v65
    v_cvt_pk_bf16_f32 v17, v66, v67
    v_cvt_pk_bf16_f32 v18, v68, v69
    v_cvt_pk_bf16_f32 v19, v70, v71
    v_lshlrev_b32 v64, 16, v16
    v_and_b32 v65, 0xffff0000, v16
    v_lshlrev_b32 v66, 16, v17
    v_and_b32 v67, 0xffff0000, v17
    v_lshlrev_b32 v68, 16, v18
    v_and_b32 v69, 0xffff0000, v18
    v_lshlrev_b32 v70, 16, v19
    v_and_b32 v71, 0xffff0000, v19
    v_mul_f32 v64, v64, v52
    v_mul_f32 v65, v65, v52
    v_mul_f32 v66, v66, v52
    v_mul_f32 v67, v67, v52
    v_mul_f32 v68, v68, v52
    v_mul_f32 v69, v69, v52
    v_mul_f32 v70, v70, v52
    v_mul_f32 v71, v71, v52
    v_cvt_pk_bf16_f32 v16, v64, v65
    v_cvt_pk_bf16_f32 v17, v66, v67
    v_cvt_pk_bf16_f32 v18, v68, v69
    v_cvt_pk_bf16_f32 v19, v70, v71
    buffer_store_dwordx4 v[16:19], v7, s[8:11], 0 offen offset:0
    v_dot2_f32_bf16 v64, v20, v5, v49
    v_dot2_f32_bf16 v65, v20, v6, v49
    v_dot2_f32_bf16 v66, v21, v5, v49
    v_dot2_f32_bf16 v67, v21, v6, v49
    v_dot2_f32_bf16 v68, v22, v5, v49
    v_dot2_f32_bf16 v69, v22, v6, v49
    v_dot2_f32_bf16 v70, v23, v5, v49
    v_dot2_f32_bf16 v71, v23, v6, v49
    v_cvt_pk_bf16_f32 v20, v64, v65
    v_cvt_pk_bf16_f32 v21, v66, v67
    v_cvt_pk_bf16_f32 v22, v68, v69
    v_cvt_pk_bf16_f32 v23, v70, v71
    v_lshlrev_b32 v64, 16, v20
    v_and_b32 v65, 0xffff0000, v20
    v_lshlrev_b32 v66, 16, v21
    v_and_b32 v67, 0xffff0000, v21
    v_lshlrev_b32 v68, 16, v22
    v_and_b32 v69, 0xffff0000, v22
    v_lshlrev_b32 v70, 16, v23
    v_and_b32 v71, 0xffff0000, v23
    v_mul_f32 v64, v64, v53
    v_mul_f32 v65, v65, v53
    v_mul_f32 v66, v66, v53
    v_mul_f32 v67, v67, v53
    v_mul_f32 v68, v68, v53
    v_mul_f32 v69, v69, v53
    v_mul_f32 v70, v70, v53
    v_mul_f32 v71, v71, v53
    v_cvt_pk_bf16_f32 v20, v64, v65
    v_cvt_pk_bf16_f32 v21, v66, v67
    v_cvt_pk_bf16_f32 v22, v68, v69
    v_cvt_pk_bf16_f32 v23, v70, v71
    buffer_store_dwordx4 v[20:23], v7, s[8:11], 0 offen offset:16
    v_dot2_f32_bf16 v64, v24, v5, v50
    v_dot2_f32_bf16 v65, v24, v6, v50
    v_dot2_f32_bf16 v66, v25, v5, v50
    v_dot2_f32_bf16 v67, v25, v6, v50
    v_dot2_f32_bf16 v68, v26, v5, v50
    v_dot2_f32_bf16 v69, v26, v6, v50
    v_dot2_f32_bf16 v70, v27, v5, v50
    v_dot2_f32_bf16 v71, v27, v6, v50
    v_cvt_pk_bf16_f32 v24, v64, v65
    v_cvt_pk_bf16_f32 v25, v66, v67
    v_cvt_pk_bf16_f32 v26, v68, v69
    v_cvt_pk_bf16_f32 v27, v70, v71
    v_lshlrev_b32 v64, 16, v24
    v_and_b32 v65, 0xffff0000, v24
    v_lshlrev_b32 v66, 16, v25
    v_and_b32 v67, 0xffff0000, v25
    v_lshlrev_b32 v68, 16, v26
    v_and_b32 v69, 0xffff0000, v26
    v_lshlrev_b32 v70, 16, v27
    v_and_b32 v71, 0xffff0000, v27
    v_mul_f32 v64, v64, v54
    v_mul_f32 v65, v65, v54
    v_mul_f32 v66, v66, v54
    v_mul_f32 v67, v67, v54
    v_mul_f32 v68, v68, v54
    v_mul_f32 v69, v69, v54
    v_mul_f32 v70, v70, v54
    v_mul_f32 v71, v71, v54
    v_cvt_pk_bf16_f32 v24, v64, v65
    v_cvt_pk_bf16_f32 v25, v66, v67
    v_cvt_pk_bf16_f32 v26, v68, v69
    v_cvt_pk_bf16_f32 v27, v70, v71
    buffer_store_dwordx4 v[24:27], v7, s[8:11], 0 offen offset:32
    v_dot2_f32_bf16 v64, v28, v5, v51
    v_dot2_f32_bf16 v65, v28, v6, v51
    v_dot2_f32_bf16 v66, v29, v5, v51
    v_dot2_f32_bf16 v67, v29, v6, v51
    v_dot2_f32_bf16 v68, v30, v5, v51
    v_dot2_f32_bf16 v69, v30, v6, v51
    v_dot2_f32_bf16 v70, v31, v5, v51
    v_dot2_f32_bf16 v71, v31, v6, v51
    v_cvt_pk_bf16_f32 v28, v64, v65
    v_cvt_pk_bf16_f32 v29, v66, v67
    v_cvt_pk_bf16_f32 v30, v68, v69
    v_cvt_pk_bf16_f32 v31, v70, v71
    v_lshlrev_b32 v64, 16, v28
    v_and_b32 v65, 0xffff0000, v28
    v_lshlrev_b32 v66, 16, v29
    v_and_b32 v67, 0xffff0000, v29
    v_lshlrev_b32 v68, 16, v30
    v_and_b32 v69, 0xffff0000, v30
    v_lshlrev_b32 v70, 16, v31
    v_and_b32 v71, 0xffff0000, v31
    v_mul_f32 v64, v64, v55
    v_mul_f32 v65, v65, v55
    v_mul_f32 v66, v66, v55
    v_mul_f32 v67, v67, v55
    v_mul_f32 v68, v68, v55
    v_mul_f32 v69, v69, v55
    v_mul_f32 v70, v70, v55
    v_mul_f32 v71, v71, v55
    v_cvt_pk_bf16_f32 v28, v64, v65
    v_cvt_pk_bf16_f32 v29, v66, v67
    v_cvt_pk_bf16_f32 v30, v68, v69
    v_cvt_pk_bf16_f32 v31, v70, v71
    buffer_store_dwordx4 v[28:31], v7, s[8:11], 0 offen offset:48
    s_lshl_b32 s4, s3, 3
    s_add_u32 s4, s4, 22020096
    v_mov_b32 v8, s4
    s_mov_b64 exec, 1
    buffer_store_dwordx4 v[56:59], v8, s[8:11], 0 offen
    buffer_store_dwordx4 v[60:63], v8, s[8:11], 0 offen offset:16
    s_endpgm
K0_NOTLN:
    s_nop 1
    s_cmp_ge_u32 s2, 256
    s_cbranch_scc0 K0_GLU
    s_sub_u32 s3, s2, 256
    s_lshl_b32 s3, s3, 2
    s_add_u32 s3, s3, s42
    v_lshlrev_b32 v3, 4, v1
    s_lshl_b32 s4, s3, 11
    s_mul_i32 s5, s3, 7168
    s_mov_b32 s12, s70
    s_and_b32 s13, s71, 0xffff
    s_mov_b32 s14, 524288
    s_mov_b32 s15, 0x00020000
    buffer_load_dwordx4 v[16:19], v3, s[12:15], s4 offen
    buffer_load_dwordx4 v[20:23], v3, s[12:15], s4 offen offset:1024
    s_nop 3
    s_mov_b32 s12, s72
    s_and_b32 s13, s73, 0xffff
    s_mov_b32 s14, 524288
    s_mov_b32 s15, 0x00020000
    buffer_load_dwordx4 v[24:27], v3, s[12:15], s4 offen
    buffer_load_dwordx4 v[28:31], v3, s[12:15], s4 offen offset:1024
    s_nop 3
    s_mov_b32 s12, s74
    s_and_b32 s13, s75, 0xffff
    s_mov_b32 s14, 524288
    s_mov_b32 s15, 0x00020000
    buffer_load_dwordx4 v[32:35], v3, s[12:15], s4 offen
    buffer_load_dwordx4 v[36:39], v3, s[12:15], s4 offen offset:1024
    s_nop 3
    s_mov_b32 s12, s76
    s_and_b32 s13, s77, 0xffff
    s_mov_b32 s14, 524288
    s_mov_b32 s15, 0x00020000
    buffer_load_dwordx4 v[40:43], v3, s[12:15], s4 offen
    buffer_load_dwordx4 v[44:47], v3, s[12:15], s4 offen offset:1024
    s_nop 3
    s_mov_b32 s16, s88
    s_and_b32 s17, s89, 0xffff
    s_mov_b32 s18, 1835008
    s_mov_b32 s19, 0x00020000
    s_add_u32 s6, s5, 0
    buffer_load_dwordx4 v[48:51], v3, s[16:19], s6 offen
    s_add_u32 s6, s5, 1024
    buffer_load_dwordx4 v[52:55], v3, s[16:19], s6 offen
    s_add_u32 s6, s5, 2048
    buffer_load_dwordx4 v[56:59], v3, s[16:19], s6 offen
    s_add_u32 s6, s5, 3072
    buffer_load_dwordx4 v[60:63], v3, s[16:19], s6 offen
    s_add_u32 s6, s5, 4096
    buffer_load_dwordx4 v[48:51], v3, s[16:19], s6 offen
    s_add_u32 s6, s5, 5120
    buffer_load_dwordx4 v[52:55], v3, s[16:19], s6 offen
    s_add_u32 s6, s5, 6144
    buffer_load_dwordx4 v[56:59], v3, s[16:19], s6 offen
    s_waitcnt vmcnt(0)
    s_endpgm
K0_GLU:
    s_nop 1
    s_sub_u32 s3, s2, 128
    s_lshr_b32 s4, s3, 2
    s_and_b32 s5, s3, 3
    s_cmp_lt_u32 s42, 2
    s_cselect_b32 s12, s84, s86
    s_cselect_b32 s13, s85, s87
    s_cselect_b32 s7, 0, 14336
    s_and_b32 s13, s13, 0xffff
    s_mov_b32 s14, 1835008
    s_mov_b32 s15, 0x00020000
    s_and_b32 s6, s42, 1
    s_mul_i32 s6, s6, 7
    s_mul_i32 s20, s4, 57344
    s_mul_i32 s21, s5, 896
    s_add_u32 s20, s20, s21
    s_movk_i32 s22, 1171
    s_movk_i32 s23, 3584
    s_add_u32 s24, s6, 0
    s_lshl_b32 s25, s24, 6
    v_add_u32 v3, s25, v1
    v_mul_lo_u32 v4, v3, s22
    v_lshrrev_b32 v4, 16, v4
    v_mul_u32_u24 v5, 56, v4
    v_sub_u32 v5, v3, v5
    v_mul_lo_u32 v4, v4, s23
    v_lshl_add_u32 v4, v5, 4, v4
    s_lshl_b32 s25, s24, 10
    s_add_u32 m0, s25, s7
    s_nop 0
    buffer_load_dwordx4 v4, s[12:15], s20 offen lds
    s_add_u32 s24, s6, 1
    s_lshl_b32 s25, s24, 6
    v_add_u32 v3, s25, v1
    v_mul_lo_u32 v4, v3, s22
    v_lshrrev_b32 v4, 16, v4
    v_mul_u32_u24 v5, 56, v4
    v_sub_u32 v5, v3, v5
    v_mul_lo_u32 v4, v4, s23
    v_lshl_add_u32 v4, v5, 4, v4
    s_lshl_b32 s25, s24, 10
    s_add_u32 m0, s25, s7
    s_nop 0
    buffer_load_dwordx4 v4, s[12:15], s20 offen lds
    s_add_u32 s24, s6, 2
    s_lshl_b32 s25, s24, 6
    v_add_u32 v3, s25, v1
    v_mul_lo_u32 v4, v3, s22
    v_lshrrev_b32 v4, 16, v4
    v_mul_u32_u24 v5, 56, v4
    v_sub_u32 v5, v3, v5
    v_mul_lo_u32 v4, v4, s23
    v_lshl_add_u32 v4, v5, 4, v4
    s_lshl_b32 s25, s24, 10
    s_add_u32 m0, s25, s7
    s_nop 0
    buffer_load_dwordx4 v4, s[12:15], s20 offen lds
    s_add_u32 s24, s6, 3
    s_lshl_b32 s25, s24, 6
    v_add_u32 v3, s25, v1
    v_mul_lo_u32 v4, v3, s22
    v_lshrrev_b32 v4, 16, v4
    v_mul_u32_u24 v5, 56, v4
    v_sub_u32 v5, v3, v5
    v_mul_lo_u32 v4, v4, s23
    v_lshl_add_u32 v4, v5, 4, v4
    s_lshl_b32 s25, s24, 10
    s_add_u32 m0, s25, s7
    s_nop 0
    buffer_load_dwordx4 v4, s[12:15], s20 offen lds
    s_add_u32 s24, s6, 4
    s_lshl_b32 s25, s24, 6
    v_add_u32 v3, s25, v1
    v_mul_lo_u32 v4, v3, s22
    v_lshrrev_b32 v4, 16, v4
    v_mul_u32_u24 v5, 56, v4
    v_sub_u32 v5, v3, v5
    v_mul_lo_u32 v4, v4, s23
    v_lshl_add_u32 v4, v5, 4, v4
    s_lshl_b32 s25, s24, 10
    s_add_u32 m0, s25, s7
    s_nop 0
    buffer_load_dwordx4 v4, s[12:15], s20 offen lds
    s_add_u32 s24, s6, 5
    s_lshl_b32 s25, s24, 6
    v_add_u32 v3, s25, v1
    v_mul_lo_u32 v4, v3, s22
    v_lshrrev_b32 v4, 16, v4
    v_mul_u32_u24 v5, 56, v4
    v_sub_u32 v5, v3, v5
    v_mul_lo_u32 v4, v4, s23
    v_lshl_add_u32 v4, v5, 4, v4
    s_lshl_b32 s25, s24, 10
    s_add_u32 m0, s25, s7
    s_nop 0
    buffer_load_dwordx4 v4, s[12:15], s20 offen lds
    s_add_u32 s24, s6, 6
    s_lshl_b32 s25, s24, 6
    v_add_u32 v3, s25, v1
    v_mul_lo_u32 v4, v3, s22
    v_lshrrev_b32 v4, 16, v4
    v_mul_u32_u24 v5, 56, v4
    v_sub_u32 v5, v3, v5
    v_mul_lo_u32 v4, v4, s23
    v_lshl_add_u32 v4, v5, 4, v4
    s_lshl_b32 s25, s24, 10
    s_add_u32 m0, s25, s7
    s_nop 0
    buffer_load_dwordx4 v4, s[12:15], s20 offen lds
    v_lshrrev_b32 v7, 4, v1
    v_and_b32 v8, 1, v7
    v_lshrrev_b32 v9, 1, v7
    v_bfe_u32 v10, v1, 2, 2
    v_lshl_add_u32 v10, v9, 3, v10
    v_mul_u32_u24 v10, 896, v10
    v_mul_u32_u24 v8, 14336, v8
    v_add_u32 v10, v10, v8
    v_and_b32 v11, 1, v1
    v_bfe_u32 v12, v1, 1, 1
    v_lshl_add_u32 v10, v11, 4, v10
    v_lshl_add_u32 v10, v12, 3, v10
    s_mul_i32 s24, s42, 224
    v_add_u32 v10, s24, v10
    s_lshl_b32 s24, s5, 2
    s_add_u32 s24, s24, s42
    s_mul_i32 s24, s24, 294912
    s_lshl_b32 s25, s4, 10
    s_add_u32 s24, s24, s25
    s_add_u32 s24, s24, 2097152
    v_lshlrev_b32 v11, 4, v1
    v_add_u32 v11, s24, v11
    s_waitcnt vmcnt(0)
    s_barrier
    ds_read_b64_tr_b16 v[16:17], v10 offset:0
    ds_read_b64_tr_b16 v[18:19], v10 offset:3584
    ds_read_b64_tr_b16 v[20:21], v10 offset:32
    ds_read_b64_tr_b16 v[22:23], v10 offset:3616
    ds_read_b64_tr_b16 v[24:25], v10 offset:64
    ds_read_b64_tr_b16 v[26:27], v10 offset:3648
    ds_read_b64_tr_b16 v[28:29], v10 offset:96
    ds_read_b64_tr_b16 v[30:31], v10 offset:3680
    ds_read_b64_tr_b16 v[32:33], v10 offset:128
    ds_read_b64_tr_b16 v[34:35], v10 offset:3712
    ds_read_b64_tr_b16 v[36:37], v10 offset:160
    ds_read_b64_tr_b16 v[38:39], v10 offset:3744
    ds_read_b64_tr_b16 v[40:41], v10 offset:192
    ds_read_b64_tr_b16 v[42:43], v10 offset:3776
    s_waitcnt lgkmcnt(12)
    s_mov_b32 s25, 0
    buffer_store_dwordx4 v[16:19], v11, s[8:11], s25 offen
    s_waitcnt lgkmcnt(10)
    s_mov_b32 s25, 32768
    buffer_store_dwordx4 v[20:23], v11, s[8:11], s25 offen
    s_waitcnt lgkmcnt(8)
    s_mov_b32 s25, 65536
    buffer_store_dwordx4 v[24:27], v11, s[8:11], s25 offen
    s_waitcnt lgkmcnt(6)
    s_mov_b32 s25, 98304
    buffer_store_dwordx4 v[28:31], v11, s[8:11], s25 offen
    s_waitcnt lgkmcnt(4)
    s_mov_b32 s25, 131072
    buffer_store_dwordx4 v[32:35], v11, s[8:11], s25 offen
    s_waitcnt lgkmcnt(2)
    s_mov_b32 s25, 163840
    buffer_store_dwordx4 v[36:39], v11, s[8:11], s25 offen
    s_waitcnt lgkmcnt(0)
    s_mov_b32 s25, 196608
    buffer_store_dwordx4 v[40:43], v11, s[8:11], s25 offen
    s_endpgm
K0_END:
    s_endpgm

.globl ssm_k1_kernel
.p2align 8
.type ssm_k1_kernel,@function
ssm_k1_kernel:
    s_cmp_ge_u32 s2, 256
    s_cbranch_scc1 K1_END
    s_load_dwordx16 s[64:79], s[0:1], 0
    s_load_dwordx16 s[80:95], s[0:1], 64
    v_and_b32 v1, 63, v0
    v_lshrrev_b32 v2, 6, v0
    s_nop 0
    v_readfirstlane_b32 s42, v2
    s_lshr_b32 s3, s2, 3
    s_bfe_u32 s4, s2, 0x20001
    s_lshl_b32 s4, s4, 2
    s_and_b32 s5, s3, 3
    s_add_u32 s40, s4, s5
    s_and_b32 s4, s2, 1
    s_lshl_b32 s4, s4, 3
    s_lshr_b32 s5, s3, 2
    s_add_u32 s41, s4, s5
    v_lshlrev_b32 v6, 4, v1
    v_and_b32 v3, 31, v1
    v_lshrrev_b32 v4, 5, v1
    s_waitcnt lgkmcnt(0)
    s_mov_b32 s8, s94
    s_and_b32 s9, s95, 0xffff
    s_mov_b32 s10, 33554432
    s_mov_b32 s11, 0x00020000
    s_cmp_ge_u32 s42, 4
    s_cbranch_scc1 K1_COMPUTE
    s_mul_i32 s43, s41, 294912
    s_lshl_b32 s44, s42, 13
    s_add_u32 s43, s43, s44
    s_add_u32 s43, s43, 2097152
    s_mov_b32 s32, s70
    s_and_b32 s33, s71, 0xffff
    s_mov_b32 s34, 524288
    s_mov_b32 s35, 0x00020000
    s_mov_b32 s36, s72
    s_and_b32 s37, s73, 0xffff
    s_mov_b32 s38, 524288
    s_mov_b32 s39, 0x00020000
    s_lshl_b32 s4, s41, 5
    s_lshl_b32 s5, s42, 3
    s_add_u32 s4, s4, s5
    s_lshl_b32 s47, s4, 10
    s_lshl_b32 s5, s42, 2
    s_add_u32 s6, s5, 0
    s_and_b32 s6, s6, 7
    v_xor_b32 v88, s6, v1
    v_lshlrev_b32 v88, 4, v88
    s_add_u32 s6, s5, 1
    s_and_b32 s6, s6, 7
    v_xor_b32 v89, s6, v1
    v_lshlrev_b32 v89, 4, v89
    s_add_u32 s6, s5, 2
    s_and_b32 s6, s6, 7
    v_xor_b32 v90, s6, v1
    v_lshlrev_b32 v90, 4, v90
    s_add_u32 s6, s5, 3
    s_and_b32 s6, s6, 7
    v_xor_b32 v91, s6, v1
    v_lshlrev_b32 v91, 4, v91
    s_add_u32 m0, s44, 0
    s_add_u32 s45, s43, 0
    buffer_load_dwordx4 v6, s[8:11], s45 offen lds
    s_add_u32 m0, s44, 1024
    s_add_u32 s45, s43, 1024
    buffer_load_dwordx4 v6, s[8:11], s45 offen lds
    s_add_u32 m0, s44, 2048
    s_add_u32 s45, s43, 2048
    buffer_load_dwordx4 v6, s[8:11], s45 offen lds
    s_add_u32 m0, s44, 3072
    s_add_u32 s45, s43, 3072
    buffer_load_dwordx4 v6, s[8:11], s45 offen lds
    s_add_u32 m0, s44, 4096
    s_add_u32 s45, s43, 4096
    buffer_load_dwordx4 v6, s[8:11], s45 offen lds
    s_add_u32 m0, s44, 5120
    s_add_u32 s45, s43, 5120
    buffer_load_dwordx4 v6, s[8:11], s45 offen lds
    s_add_u32 m0, s44, 6144
    s_add_u32 s45, s43, 6144
    buffer_load_dwordx4 v6, s[8:11], s45 offen lds
    s_add_u32 m0, s44, 7168
    s_add_u32 s45, s43, 7168
    buffer_load_dwordx4 v6, s[8:11], s45 offen lds
    s_add_u32 m0, s44, 32768
    s_add_u32 s45, s43, 32768
    buffer_load_dwordx4 v6, s[8:11], s45 offen lds
    s_add_u32 m0, s44, 33792
    s_add_u32 s45, s43, 33792
    buffer_load_dwordx4 v6, s[8:11], s45 offen lds
    s_add_u32 m0, s44, 34816
    s_add_u32 s45, s43, 34816
    buffer_load_dwordx4 v6, s[8:11], s45 offen lds
    s_add_u32 m0, s44, 35840
    s_add_u32 s45, s43, 35840
    buffer_load_dwordx4 v6, s[8:11], s45 offen lds
    s_add_u32 m0, s44, 36864
    s_add_u32 s45, s43, 36864
    buffer_load_dwordx4 v6, s[8:11], s45 offen lds
    s_add_u32 m0, s44, 37888
    s_add_u32 s45, s43, 37888
    buffer_load_dwordx4 v6, s[8:11], s45 offen lds
    s_add_u32 m0, s44, 38912
    s_add_u32 s45, s43, 38912
    buffer_load_dwordx4 v6, s[8:11], s45 offen lds
    s_add_u32 m0, s44, 39936
    s_add_u32 s45, s43, 39936
    buffer_load_dwordx4 v6, s[8:11], s45 offen lds
    s_mov_b32 s12, s92
    s_and_b32 s13, s93, 0xffff
    s_mov_b32 s14, 256
    s_mov_b32 s15, 0x00020000
    s_mov_b32 s16, s66
    s_and_b32 s17, s67, 0xffff
    s_mov_b32 s18, 1024
    s_mov_b32 s19, 0x00020000
    s_mov_b32 s20, s68
    s_and_b32 s21, s69, 0xffff
    s_mov_b32 s22, 1024
    s_mov_b32 s23, 0x00020000
    s_mov_b32 s24, s78
    s_and_b32 s25, s79, 0xffff
    s_mov_b32 s26, 1024
    s_mov_b32 s27, 0x00020000
    s_lshl_b32 s4, s41, 5
    v_add_u32 v7, s4, v3
    v_lshlrev_b32 v7, 1, v7
    buffer_load_ushort v24, v7, s[16:19], 0 offen
    buffer_load_ushort v25, v7, s[20:23], 0 offen
    buffer_load_ushort v26, v7, s[24:27], 0 offen
    s_lshl_b32 s3, s41, 12
    s_add_u32 s3, s3, 22085632
    s_add_u32 s28, s94, s3
    s_addc_u32 s29, s95, 0
    s_and_b32 s29, s29, 0xffff
    s_mov_b32 s30, 4096
    s_mov_b32 s31, 0x00020000
    s_waitcnt vmcnt(11)
    s_waitcnt vmcnt(3)
    s_barrier
    s_add_u32 m0, s44, 65536
    s_add_u32 s45, s47, 0
    buffer_load_dwordx4 v88, s[32:35], s45 offen lds
    s_add_u32 m0, s44, 66560
    s_add_u32 s45, s47, 1024
    buffer_load_dwordx4 v88, s[32:35], s45 offen lds
    s_add_u32 m0, s44, 67584
    s_add_u32 s45, s47, 2048
    buffer_load_dwordx4 v89, s[32:35], s45 offen lds
    s_add_u32 m0, s44, 68608
    s_add_u32 s45, s47, 3072
    buffer_load_dwordx4 v89, s[32:35], s45 offen lds
    s_add_u32 m0, s44, 69632
    s_add_u32 s45, s47, 4096
    buffer_load_dwordx4 v90, s[32:35], s45 offen lds
    s_add_u32 m0, s44, 70656
    s_add_u32 s45, s47, 5120
    buffer_load_dwordx4 v90, s[32:35], s45 offen lds
    s_add_u32 m0, s44, 71680
    s_add_u32 s45, s47, 6144
    buffer_load_dwordx4 v91, s[32:35], s45 offen lds
    s_add_u32 m0, s44, 72704
    s_add_u32 s45, s47, 7168
    buffer_load_dwordx4 v91, s[32:35], s45 offen lds
    s_waitcnt vmcnt(8)
    v_lshlrev_b32 v24, 16, v24
    v_lshlrev_b32 v25, 16, v25
    v_lshlrev_b32 v26, 16, v26
    v_mul_f32 v26, 0x3fb8aa3b, v26
    v_exp_f32 v26, v26
    s_nop 0
    v_cvt_pk_bf16_f32 v26, v26, v26
    v_lshlrev_b32 v26, 16, v26
    v_mul_f32 v8, v26, v24
    v_mul_f32 v9, v26, v25
    v_mul_f32 v8, 0x3fb8aa3b, v8
    v_exp_f32 v8, v8
    v_mul_f32 v9, 0x3e22f983, v9
    v_fract_f32 v9, v9
    v_cos_f32 v10, v9
    v_sin_f32 v11, v9
    v_mul_f32 v10, v8, v10
    v_mul_f32 v11, v8, v11
    v_add_f32 v12, -1.0, v10
    v_mul_f32 v13, v24, v24
    v_fma_f32 v13, v25, v25, v13
    v_rcp_f32 v14, v13
    s_nop 0
    v_fma_f32 v15, -v13, v14, 1.0
    v_fma_f32 v14, v15, v14, v14
    v_add_f32 v14, v14, v14
    v_mul_f32 v15, v12, v24
    v_fma_f32 v15, v11, v25, v15
    v_mul_f32 v16, v11, v24
    v_fma_f32 v16, -v12, v25, v16
    v_mul_f32 v12, v15, v14
    v_mul_f32 v13, v16, v14
    v_mul_f32 v18, v11, v11
    v_mul_f32 v19, v10, v11
    v_fma_f32 v14, v10, v10, -v18
    v_add_f32 v15, v19, v19
    v_mul_f32 v18, v15, v15
    v_mul_f32 v19, v14, v15
    v_fma_f32 v14, v14, v14, -v18
    v_add_f32 v15, v19, v19
    v_mul_f32 v18, v15, v15
    v_mul_f32 v19, v14, v15
    v_fma_f32 v14, v14, v14, -v18
    v_add_f32 v15, v19, v19
    v_mul_f32 v18, v15, v15
    v_mul_f32 v19, v14, v15
    v_fma_f32 v14, v14, v14, -v18
    v_add_f32 v15, v19, v19
    v_mul_f32 v18, v15, v15
    v_mul_f32 v19, v14, v15
    v_fma_f32 v16, v14, v14, -v18
    v_add_f32 v17, v19, v19
    v_mul_f32 v18, v17, v17
    v_mul_f32 v19, v16, v17
    v_fma_f32 v16, v16, v16, -v18
    v_add_f32 v17, v19, v19
    v_mul_f32 v18, v17, v17
    v_mul_f32 v19, v16, v17
    v_fma_f32 v16, v16, v16, -v18
    v_add_f32 v17, v19, v19
    s_lshl_b32 s3, s42, 1
    v_add_u32 v20, s3, v4
    v_mul_u32_u24 v21, 4352, v20
    v_lshl_add_u32 v21, v3, 2, v21
    v_add_u32 v21, 98304, v21
    v_lshlrev_b32 v22, 8, v20
    v_lshl_add_u32 v22, v3, 3, v22
    v_add_u32 v22, 133120, v22
    v_lshlrev_b32 v23, 3, v3
    v_add_u32 v23, 133120, v23
    s_waitcnt vmcnt(0)
    s_barrier
    s_add_u32 m0, s44, 0
    s_add_u32 s45, s47, 0
    buffer_load_dwordx4 v88, s[36:39], s45 offen lds
    s_add_u32 m0, s44, 1024
    s_add_u32 s45, s47, 1024
    buffer_load_dwordx4 v88, s[36:39], s45 offen lds
    s_add_u32 m0, s44, 2048
    s_add_u32 s45, s47, 2048
    buffer_load_dwordx4 v89, s[36:39], s45 offen lds
    s_add_u32 m0, s44, 3072
    s_add_u32 s45, s47, 3072
    buffer_load_dwordx4 v89, s[36:39], s45 offen lds
    s_add_u32 m0, s44, 4096
    s_add_u32 s45, s47, 4096
    buffer_load_dwordx4 v90, s[36:39], s45 offen lds
    s_add_u32 m0, s44, 5120
    s_add_u32 s45, s47, 5120
    buffer_load_dwordx4 v90, s[36:39], s45 offen lds
    s_add_u32 m0, s44, 6144
    s_add_u32 s45, s47, 6144
    buffer_load_dwordx4 v91, s[36:39], s45 offen lds
    s_add_u32 m0, s44, 7168
    s_add_u32 s45, s47, 7168
    buffer_load_dwordx4 v91, s[36:39], s45 offen lds
    s_add_u32 m0, s44, 32768
    s_add_u32 s45, s43, 65536
    buffer_load_dwordx4 v6, s[8:11], s45 offen lds
    s_add_u32 m0, s44, 33792
    s_add_u32 s45, s43, 66560
    buffer_load_dwordx4 v6, s[8:11], s45 offen lds
    s_add_u32 m0, s44, 34816
    s_add_u32 s45, s43, 67584
    buffer_load_dwordx4 v6, s[8:11], s45 offen lds
    s_add_u32 m0, s44, 35840
    s_add_u32 s45, s43, 68608
    buffer_load_dwordx4 v6, s[8:11], s45 offen lds
    s_add_u32 m0, s44, 36864
    s_add_u32 s45, s43, 69632
    buffer_load_dwordx4 v6, s[8:11], s45 offen lds
    s_add_u32 m0, s44, 37888
    s_add_u32 s45, s43, 70656
    buffer_load_dwordx4 v6, s[8:11], s45 offen lds
    s_add_u32 m0, s44, 38912
    s_add_u32 s45, s43, 71680
    buffer_load_dwordx4 v6, s[8:11], s45 offen lds
    s_add_u32 m0, s44, 39936
    s_add_u32 s45, s43, 72704
    buffer_load_dwordx4 v6, s[8:11], s45 offen lds
    s_waitcnt vmcnt(8)
    s_barrier
    s_add_u32 m0, s44, 65536
    s_add_u32 s45, s43, 98304
    buffer_load_dwordx4 v6, s[8:11], s45 offen lds
    s_add_u32 m0, s44, 66560
    s_add_u32 s45, s43, 99328
    buffer_load_dwordx4 v6, s[8:11], s45 offen lds
    s_add_u32 m0, s44, 67584
    s_add_u32 s45, s43, 100352
    buffer_load_dwordx4 v6, s[8:11], s45 offen lds
    s_add_u32 m0, s44, 68608
    s_add_u32 s45, s43, 101376
    buffer_load_dwordx4 v6, s[8:11], s45 offen lds
    s_add_u32 m0, s44, 69632
    s_add_u32 s45, s43, 102400
    buffer_load_dwordx4 v6, s[8:11], s45 offen lds
    s_add_u32 m0, s44, 70656
    s_add_u32 s45, s43, 103424
    buffer_load_dwordx4 v6, s[8:11], s45 offen lds
    s_add_u32 m0, s44, 71680
    s_add_u32 s45, s43, 104448
    buffer_load_dwordx4 v6, s[8:11], s45 offen lds
    s_add_u32 m0, s44, 72704
    s_add_u32 s45, s43, 105472
    buffer_load_dwordx4 v6, s[8:11], s45 offen lds
    s_waitcnt vmcnt(8)
    s_barrier
    s_add_u32 m0, s44, 0
    s_add_u32 s45, s43, 131072
    buffer_load_dwordx4 v6, s[8:11], s45 offen lds
    s_add_u32 m0, s44, 1024
    s_add_u32 s45, s43, 132096
    buffer_load_dwordx4 v6, s[8:11], s45 offen lds
    s_add_u32 m0, s44, 2048
    s_add_u32 s45, s43, 133120
    buffer_load_dwordx4 v6, s[8:11], s45 offen lds
    s_add_u32 m0, s44, 3072
    s_add_u32 s45, s43, 134144
    buffer_load_dwordx4 v6, s[8:11], s45 offen lds
    s_add_u32 m0, s44, 4096
    s_add_u32 s45, s43, 135168
    buffer_load_dwordx4 v6, s[8:11], s45 offen lds
    s_add_u32 m0, s44, 5120
    s_add_u32 s45, s43, 136192
    buffer_load_dwordx4 v6, s[8:11], s45 offen lds
    s_add_u32 m0, s44, 6144
    s_add_u32 s45, s43, 137216
    buffer_load_dwordx4 v6, s[8:11], s45 offen lds
    s_add_u32 m0, s44, 7168
    s_add_u32 s45, s43, 138240
    buffer_load_dwordx4 v6, s[8:11], s45 offen lds
    s_waitcnt vmcnt(8)
    s_barrier
    s_add_u32 m0, s44, 32768
    s_add_u32 s45, s43, 163840
    buffer_load_dwordx4 v6, s[8:11], s45 offen lds
    s_add_u32 m0, s44, 33792
    s_add_u32 s45, s43, 164864
    buffer_load_dwordx4 v6, s[8:11], s45 offen lds
    s_add_u32 m0, s44, 34816
    s_add_u32 s45, s43, 165888
    buffer_load_dwordx4 v6, s[8:11], s45 offen lds
    s_add_u32 m0, s44, 35840
    s_add_u32 s45, s43, 166912
    buffer_load_dwordx4 v6, s[8:11], s45 offen lds
    s_add_u32 m0, s44, 36864
    s_add_u32 s45, s43, 167936
    buffer_load_dwordx4 v6, s[8:11], s45 offen lds
    s_add_u32 m0, s44, 37888
    s_add_u32 s45, s43, 168960
    buffer_load_dwordx4 v6, s[8:11], s45 offen lds
    s_add_u32 m0, s44, 38912
    s_add_u32 s45, s43, 169984
    buffer_load_dwordx4 v6, s[8:11], s45 offen lds
    s_add_u32 m0, s44, 39936
    s_add_u32 s45, s43, 171008
    buffer_load_dwordx4 v6, s[8:11], s45 offen lds
    ds_read_b32 v32, v21 offset:0
    ds_read_b32 v48, v21 offset:128
    ds_read_b32 v33, v21 offset:272
    ds_read_b32 v49, v21 offset:400
    ds_read_b32 v34, v21 offset:544
    ds_read_b32 v50, v21 offset:672
    ds_read_b32 v35, v21 offset:816
    ds_read_b32 v51, v21 offset:944
    ds_read_b32 v36, v21 offset:1088
    ds_read_b32 v52, v21 offset:1216
    ds_read_b32 v37, v21 offset:1360
    ds_read_b32 v53, v21 offset:1488
    ds_read_b32 v38, v21 offset:1632
    ds_read_b32 v54, v21 offset:1760
    ds_read_b32 v39, v21 offset:1904
    ds_read_b32 v55, v21 offset:2032
    ds_read_b32 v40, v21 offset:2176
    ds_read_b32 v56, v21 offset:2304
    ds_read_b32 v41, v21 offset:2448
    ds_read_b32 v57, v21 offset:2576
    ds_read_b32 v42, v21 offset:2720
    ds_read_b32 v58, v21 offset:2848
    ds_read_b32 v43, v21 offset:2992
    ds_read_b32 v59, v21 offset:3120
    ds_read_b32 v44, v21 offset:3264
    ds_read_b32 v60, v21 offset:3392
    ds_read_b32 v45, v21 offset:3536
    ds_read_b32 v61, v21 offset:3664
    ds_read_b32 v46, v21 offset:3808
    ds_read_b32 v62, v21 offset:3936
    ds_read_b32 v47, v21 offset:4080
    ds_read_b32 v63, v21 offset:4208
    s_waitcnt lgkmcnt(15)
    v_fma_f32 v33, v10, v32, v33
    v_fma_f32 v49, v10, v48, v49
    v_fma_f32 v33, -v11, v48, v33
    v_fma_f32 v49, v11, v32, v49
    v_fma_f32 v34, v10, v33, v34
    v_fma_f32 v50, v10, v49, v50
    v_fma_f32 v34, -v11, v49, v34
    v_fma_f32 v50, v11, v33, v50
    v_fma_f32 v35, v10, v34, v35
    v_fma_f32 v51, v10, v50, v51
    v_fma_f32 v35, -v11, v50, v35
    v_fma_f32 v51, v11, v34, v51
    v_fma_f32 v36, v10, v35, v36
    v_fma_f32 v52, v10, v51, v52
    v_fma_f32 v36, -v11, v51, v36
    v_fma_f32 v52, v11, v35, v52
    v_fma_f32 v37, v10, v36, v37
    v_fma_f32 v53, v10, v52, v53
    v_fma_f32 v37, -v11, v52, v37
    v_fma_f32 v53, v11, v36, v53
    v_fma_f32 v38, v10, v37, v38
    v_fma_f32 v54, v10, v53, v54
    v_fma_f32 v38, -v11, v53, v38
    v_fma_f32 v54, v11, v37, v54
    v_fma_f32 v39, v10, v38, v39
    v_fma_f32 v55, v10, v54, v55
    v_fma_f32 v39, -v11, v54, v39
    v_fma_f32 v55, v11, v38, v55
    s_waitcnt lgkmcnt(14)
    v_fma_f32 v40, v10, v39, v40
    v_fma_f32 v56, v10, v55, v56
    v_fma_f32 v40, -v11, v55, v40
    v_fma_f32 v56, v11, v39, v56
    s_waitcnt lgkmcnt(12)
    v_fma_f32 v41, v10, v40, v41
    v_fma_f32 v57, v10, v56, v57
    v_fma_f32 v41, -v11, v56, v41
    v_fma_f32 v57, v11, v40, v57
    s_waitcnt lgkmcnt(10)
    v_fma_f32 v42, v10, v41, v42
    v_fma_f32 v58, v10, v57, v58
    v_fma_f32 v42, -v11, v57, v42
    v_fma_f32 v58, v11, v41, v58
    s_waitcnt lgkmcnt(8)
    v_fma_f32 v43, v10, v42, v43
    v_fma_f32 v59, v10, v58, v59
    v_fma_f32 v43, -v11, v58, v43
    v_fma_f32 v59, v11, v42, v59
    s_waitcnt lgkmcnt(6)
    v_fma_f32 v44, v10, v43, v44
    v_fma_f32 v60, v10, v59, v60
    v_fma_f32 v44, -v11, v59, v44
    v_fma_f32 v60, v11, v43, v60
    s_waitcnt lgkmcnt(4)
    v_fma_f32 v45, v10, v44, v45
    v_fma_f32 v61, v10, v60, v61
    v_fma_f32 v45, -v11, v60, v45
    v_fma_f32 v61, v11, v44, v61
    s_waitcnt lgkmcnt(2)
    v_fma_f32 v46, v10, v45, v46
    v_fma_f32 v62, v10, v61, v62
    v_fma_f32 v46, -v11, v61, v46
    v_fma_f32 v62, v11, v45, v62
    s_waitcnt lgkmcnt(0)
    v_fma_f32 v47, v10, v46, v47
    v_fma_f32 v63, v10, v62, v63
    v_fma_f32 v47, -v11, v62, v47
    v_fma_f32 v63, v11, v46, v63
    v_mov_b32 v28, v47
    v_mov_b32 v29, v63
    ds_write_b64 v22, v[28:29]
    s_waitcnt vmcnt(8)
    s_waitcnt lgkmcnt(0)
    s_barrier
    s_add_u32 m0, s44, 65536
    s_add_u32 s45, s43, 196608
    buffer_load_dwordx4 v6, s[8:11], s45 offen lds
    s_add_u32 m0, s44, 66560
    s_add_u32 s45, s43, 197632
    buffer_load_dwordx4 v6, s[8:11], s45 offen lds
    s_add_u32 m0, s44, 67584
    s_add_u32 s45, s43, 198656
    buffer_load_dwordx4 v6, s[8:11], s45 offen lds
    s_add_u32 m0, s44, 68608
    s_add_u32 s45, s43, 199680
    buffer_load_dwordx4 v6, s[8:11], s45 offen lds
    s_add_u32 m0, s44, 69632
    s_add_u32 s45, s43, 200704
    buffer_load_dwordx4 v6, s[8:11], s45 offen lds
    s_add_u32 m0, s44, 70656
    s_add_u32 s45, s43, 201728
    buffer_load_dwordx4 v6, s[8:11], s45 offen lds
    s_add_u32 m0, s44, 71680
    s_add_u32 s45, s43, 202752
    buffer_load_dwordx4 v6, s[8:11], s45 offen lds
    s_add_u32 m0, s44, 72704
    s_add_u32 s45, s43, 203776
    buffer_load_dwordx4 v6, s[8:11], s45 offen lds
    ds_read_b64 v[64:65], v23 offset:0
    ds_read_b64 v[66:67], v23 offset:256
    ds_read_b64 v[68:69], v23 offset:512
    ds_read_b64 v[70:71], v23 offset:768
    ds_read_b64 v[72:73], v23 offset:1024
    ds_read_b64 v[74:75], v23 offset:1280
    ds_read_b64 v[76:77], v23 offset:1536
    v_mov_b32 v24, 0
    v_mov_b32 v25, 0
    v_mov_b32 v26, 1.0
    v_mov_b32 v27, 0
    s_waitcnt lgkmcnt(6)
    v_cmp_lt_u32 vcc, 0, v20
    v_fma_f32 v64, v14, v24, v64
    v_fma_f32 v65, v14, v25, v65
    v_fma_f32 v64, -v15, v25, v64
    v_fma_f32 v65, v15, v24, v65
    v_mul_f32 v28, v14, v26
    v_mul_f32 v29, v14, v27
    v_fma_f32 v28, -v15, v27, v28
    v_fma_f32 v29, v15, v26, v29
    v_cndmask_b32 v24, v24, v64, vcc
    v_cndmask_b32 v25, v25, v65, vcc
    v_cndmask_b32 v26, v26, v28, vcc
    v_cndmask_b32 v27, v27, v29, vcc
    s_waitcnt lgkmcnt(5)
    v_cmp_lt_u32 vcc, 1, v20
    v_fma_f32 v66, v14, v24, v66
    v_fma_f32 v67, v14, v25, v67
    v_fma_f32 v66, -v15, v25, v66
    v_fma_f32 v67, v15, v24, v67
    v_mul_f32 v28, v14, v26
    v_mul_f32 v29, v14, v27
    v_fma_f32 v28, -v15, v27, v28
    v_fma_f32 v29, v15, v26, v29
    v_cndmask_b32 v24, v24, v66, vcc
    v_cndmask_b32 v25, v25, v67, vcc
    v_cndmask_b32 v26, v26, v28, vcc
    v_cndmask_b32 v27, v27, v29, vcc
    s_waitcnt lgkmcnt(4)
    v_cmp_lt_u32 vcc, 2, v20
    v_fma_f32 v68, v14, v24, v68
    v_fma_f32 v69, v14, v25, v69
    v_fma_f32 v68, -v15, v25, v68
    v_fma_f32 v69, v15, v24, v69
    v_mul_f32 v28, v14, v26
    v_mul_f32 v29, v14, v27
    v_fma_f32 v28, -v15, v27, v28
    v_fma_f32 v29, v15, v26, v29
    v_cndmask_b32 v24, v24, v68, vcc
    v_cndmask_b32 v25, v25, v69, vcc
    v_cndmask_b32 v26, v26, v28, vcc
    v_cndmask_b32 v27, v27, v29, vcc
    s_waitcnt lgkmcnt(3)
    v_cmp_lt_u32 vcc, 3, v20
    v_fma_f32 v70, v14, v24, v70
    v_fma_f32 v71, v14, v25, v71
    v_fma_f32 v70, -v15, v25, v70
    v_fma_f32 v71, v15, v24, v71
    v_mul_f32 v28, v14, v26
    v_mul_f32 v29, v14, v27
    v_fma_f32 v28, -v15, v27, v28
    v_fma_f32 v29, v15, v26, v29
    v_cndmask_b32 v24, v24, v70, vcc
    v_cndmask_b32 v25, v25, v71, vcc
    v_cndmask_b32 v26, v26, v28, vcc
    v_cndmask_b32 v27, v27, v29, vcc
    s_waitcnt lgkmcnt(2)
    v_cmp_lt_u32 vcc, 4, v20
    v_fma_f32 v72, v14, v24, v72
    v_fma_f32 v73, v14, v25, v73
    v_fma_f32 v72, -v15, v25, v72
    v_fma_f32 v73, v15, v24, v73
    v_mul_f32 v28, v14, v26
    v_mul_f32 v29, v14, v27
    v_fma_f32 v28, -v15, v27, v28
    v_fma_f32 v29, v15, v26, v29
    v_cndmask_b32 v24, v24, v72, vcc
    v_cndmask_b32 v25, v25, v73, vcc
    v_cndmask_b32 v26, v26, v28, vcc
    v_cndmask_b32 v27, v27, v29, vcc
    s_waitcnt lgkmcnt(1)
    v_cmp_lt_u32 vcc, 5, v20
    v_fma_f32 v74, v14, v24, v74
    v_fma_f32 v75, v14, v25, v75
    v_fma_f32 v74, -v15, v25, v74
    v_fma_f32 v75, v15, v24, v75
    v_mul_f32 v28, v14, v26
    v_mul_f32 v29, v14, v27
    v_fma_f32 v28, -v15, v27, v28
    v_fma_f32 v29, v15, v26, v29
    v_cndmask_b32 v24, v24, v74, vcc
    v_cndmask_b32 v25, v25, v75, vcc
    v_cndmask_b32 v26, v26, v28, vcc
    v_cndmask_b32 v27, v27, v29, vcc
    s_waitcnt lgkmcnt(0)
    v_cmp_lt_u32 vcc, 6, v20
    v_fma_f32 v76, v14, v24, v76
    v_fma_f32 v77, v14, v25, v77
    v_fma_f32 v76, -v15, v25, v76
    v_fma_f32 v77, v15, v24, v77
    v_mul_f32 v28, v14, v26
    v_mul_f32 v29, v14, v27
    v_fma_f32 v28, -v15, v27, v28
    v_fma_f32 v29, v15, v26, v29
    v_cndmask_b32 v24, v24, v76, vcc
    v_cndmask_b32 v25, v25, v77, vcc
    v_cndmask_b32 v26, v26, v28, vcc
    v_cndmask_b32 v27, v27, v29, vcc
    v_fma_f32 v28, v14, v24, v47
    v_fma_f32 v29, v14, v25, v63
    v_fma_f32 v28, -v15, v25, v28
    v_fma_f32 v29, v15, v24, v29
    s_lshl_b32 s3, s40, 8
    v_lshl_add_u32 v30, v3, 3, s3
    s_lshl_b32 s4, s41, 2
    v_mov_b32 v31, s4
    s_lshl_b32 s5, 1, s40
    v_mov_b32 v7, s5
    v_or_b32 v28, 1, v28
    s_cmp_eq_u32 s42, 3
    s_cbranch_scc0 K1_NOPUB
    s_mov_b32 exec_lo, 0
    buffer_store_dwordx2 v[28:29], v30, s[28:31], 0 offen sc0 sc1
    s_mov_b64 exec, -1
K1_NOPUB:
    s_nop 1
    s_waitcnt vmcnt(8)
    s_barrier
    s_lshl_b32 s56, s2, 2
    s_add_u32 s56, s56, s42
    s_lshl_b32 s57, s42, 12
    s_add_u32 s57, s57, 135168
    s_cmp_ge_u32 s56, 448
    s_cbranch_scc1 K1_JOBC
    s_mov_b32 s48, s88
    s_and_b32 s49, s89, 0xffff
    s_mov_b32 s50, 1835008
    s_mov_b32 s51, 0x00020000
    s_lshr_b32 s4, s56, 3
    s_and_b32 s5, s56, 7
    s_lshl_b32 s6, s4, 15
    s_lshl_b32 s7, s5, 7
    s_add_u32 s6, s6, s7
    v_lshrrev_b32 v28, 3, v1
    v_lshlrev_b32 v28, 10, v28
    v_and_b32 v29, 7, v1
    v_lshl_add_u32 v28, v29, 4, v28
    s_add_u32 m0, s57, 0
    s_add_u32 s20, s6, 0
    buffer_load_dwordx4 v28, s[48:51], s20 offen lds
    s_add_u32 m0, s57, 1024
    s_add_u32 s20, s6, 8192
    buffer_load_dwordx4 v28, s[48:51], s20 offen lds
    s_add_u32 m0, s57, 2048
    s_add_u32 s20, s6, 16384
    buffer_load_dwordx4 v28, s[48:51], s20 offen lds
    s_add_u32 m0, s57, 3072
    s_add_u32 s20, s6, 24576
    buffer_load_dwordx4 v28, s[48:51], s20 offen lds
    s_mul_i32 s58, s5, 88
    s_add_u32 s58, s58, s4
    s_add_u32 s58, s58, 32
    s_lshl_b32 s58, s58, 12
    s_add_u32 s58, s58, 7340032
    s_branch K1_JOBISSUED
K1_JOBC:
    s_nop 1
    s_cmp_ge_u32 s56, 960
    s_cbranch_scc1 K1_JOBISSUED
    s_sub_u32 s3, s56, 448
    s_lshr_b32 s4, s3, 6
    s_bfe_u32 s5, s3, 0x40002
    s_bfe_u32 s6, s3, 0x10001
    s_and_b32 s7, s3, 1
    s_cmp_eq_u32 s6, 0
    s_cselect_b32 s48, s74, s76
    s_cselect_b32 s49, s75, s77
    s_and_b32 s49, s49, 0xffff
    s_mov_b32 s50, 524288
    s_mov_b32 s51, 0x00020000
    s_lshl_b32 s20, s4, 6
    s_lshl_b32 s21, s7, 5
    s_add_u32 s20, s20, s21
    v_and_b32 v28, 15, v1
    v_add_u32 v28, s20, v28
    v_lshlrev_b32 v28, 10, v28
    v_lshrrev_b32 v29, 4, v1
    v_lshl_add_u32 v28, v29, 4, v28
    s_lshl_b32 s20, s5, 6
    s_add_u32 s21, s20, 16384
    s_mov_b32 m0, s57
    s_nop 0
    buffer_load_dwordx4 v28, s[48:51], s20 offen lds
    s_add_u32 m0, s57, 1024
    s_nop 0
    buffer_load_dwordx4 v28, s[48:51], s21 offen lds
    s_mul_i32 s58, s4, 88
    s_lshl_b32 s21, s5, 1
    s_add_u32 s58, s58, s21
    s_add_u32 s58, s58, s6
    s_lshl_b32 s58, s58, 12
    s_lshl_b32 s21, s7, 11
    s_add_u32 s58, s58, s21
    s_add_u32 s58, s58, 7340032
K1_JOBISSUED:
    s_nop 1
    v_mul_f32 v28, v12, v32
    v_mul_f32 v29, v12, v48
    v_fma_f32 v28, -v13, v48, v28
    v_fma_f32 v48, -v13, v32, -v29
    v_mov_b32 v32, v28
    v_mul_f32 v28, v12, v33
    v_mul_f32 v29, v12, v49
    v_fma_f32 v28, -v13, v49, v28
    v_fma_f32 v49, -v13, v33, -v29
    v_mov_b32 v33, v28
    v_mul_f32 v28, v12, v34
    v_mul_f32 v29, v12, v50
    v_fma_f32 v28, -v13, v50, v28
    v_fma_f32 v50, -v13, v34, -v29
    v_mov_b32 v34, v28
    v_mul_f32 v28, v12, v35
    v_mul_f32 v29, v12, v51
    v_fma_f32 v28, -v13, v51, v28
    v_fma_f32 v51, -v13, v35, -v29
    v_mov_b32 v35, v28
    v_mul_f32 v28, v12, v36
    v_mul_f32 v29, v12, v52
    v_fma_f32 v28, -v13, v52, v28
    v_fma_f32 v52, -v13, v36, -v29
    v_mov_b32 v36, v28
    v_mul_f32 v28, v12, v37
    v_mul_f32 v29, v12, v53
    v_fma_f32 v28, -v13, v53, v28
    v_fma_f32 v53, -v13, v37, -v29
    v_mov_b32 v37, v28
    v_mul_f32 v28, v12, v38
    v_mul_f32 v29, v12, v54
    v_fma_f32 v28, -v13, v54, v28
    v_fma_f32 v54, -v13, v38, -v29
    v_mov_b32 v38, v28
    v_mul_f32 v28, v12, v39
    v_mul_f32 v29, v12, v55
    v_fma_f32 v28, -v13, v55, v28
    v_fma_f32 v55, -v13, v39, -v29
    v_mov_b32 v39, v28
    v_mul_f32 v28, v12, v40
    v_mul_f32 v29, v12, v56
    v_fma_f32 v28, -v13, v56, v28
    v_fma_f32 v56, -v13, v40, -v29
    v_mov_b32 v40, v28
    v_mul_f32 v28, v12, v41
    v_mul_f32 v29, v12, v57
    v_fma_f32 v28, -v13, v57, v28
    v_fma_f32 v57, -v13, v41, -v29
    v_mov_b32 v41, v28
    v_mul_f32 v28, v12, v42
    v_mul_f32 v29, v12, v58
    v_fma_f32 v28, -v13, v58, v28
    v_fma_f32 v58, -v13, v42, -v29
    v_mov_b32 v42, v28
    v_mul_f32 v28, v12, v43
    v_mul_f32 v29, v12, v59
    v_fma_f32 v28, -v13, v59, v28
    v_fma_f32 v59, -v13, v43, -v29
    v_mov_b32 v43, v28
    v_mul_f32 v28, v12, v44
    v_mul_f32 v29, v12, v60
    v_fma_f32 v28, -v13, v60, v28
    v_fma_f32 v60, -v13, v44, -v29
    v_mov_b32 v44, v28
    v_mul_f32 v28, v12, v45
    v_mul_f32 v29, v12, v61
    v_fma_f32 v28, -v13, v61, v28
    v_fma_f32 v61, -v13, v45, -v29
    v_mov_b32 v45, v28
    v_mul_f32 v28, v12, v46
    v_mul_f32 v29, v12, v62
    v_fma_f32 v28, -v13, v62, v28
    v_fma_f32 v62, -v13, v46, -v29
    v_mov_b32 v46, v28
    v_mul_f32 v28, v12, v47
    v_mul_f32 v29, v12, v63
    v_fma_f32 v28, -v13, v63, v28
    v_fma_f32 v63, -v13, v47, -v29
    v_mov_b32 v47, v28
    s_waitcnt vmcnt(0)
    s_barrier
    v_lshlrev_b32 v30, 3, v3
    s_lshl_b32 s3, s40, 1
    s_mul_i32 s3, s3, 88
    s_lshl_b32 s4, s41, 1
    s_add_u32 s3, s3, s4
    s_lshl_b32 s3, s3, 12
    s_add_u32 s3, s3, 10485760
    v_lshrrev_b32 v2, 2, v20
    v_mul_u32_u24 v2, 88, v2
    v_and_b32 v31, 1, v3
    v_add_u32 v2, v2, v31
    v_lshlrev_b32 v2, 12, v2
    v_add_u32 v2, s3, v2
    v_and_b32 v7, 3, v20
    v_lshl_add_u32 v2, v7, 10, v2
    v_lshrrev_b32 v7, 3, v3
    v_lshl_add_u32 v2, v7, 8, v2
    v_and_b32 v7, 6, v3
    v_lshl_add_u32 v2, v7, 1, v2
    v_cmp_eq_u32 vcc, 1, v31
    v_mov_b32 v28, 0
    v_mov_b32 v29, 0
K1_POLL:
    s_nop 1
    buffer_load_dwordx2 v[64:65], v30, s[28:31], 0 offen offset:0 sc0 sc1
    buffer_load_dwordx2 v[66:67], v30, s[28:31], 0 offen offset:256 sc0 sc1
    buffer_load_dwordx2 v[68:69], v30, s[28:31], 0 offen offset:512 sc0 sc1
    buffer_load_dwordx2 v[70:71], v30, s[28:31], 0 offen offset:768 sc0 sc1
    buffer_load_dwordx2 v[72:73], v30, s[28:31], 0 offen offset:1024 sc0 sc1
    buffer_load_dwordx2 v[74:75], v30, s[28:31], 0 offen offset:1280 sc0 sc1
    buffer_load_dwordx2 v[76:77], v30, s[28:31], 0 offen offset:1536 sc0 sc1
    buffer_load_dwordx2 v[78:79], v30, s[28:31], 0 offen offset:1792 sc0 sc1
    buffer_load_dwordx2 v[80:81], v30, s[28:31], 0 offen offset:2048 sc0 sc1
    buffer_load_dwordx2 v[82:83], v30, s[28:31], 0 offen offset:2304 sc0 sc1
    buffer_load_dwordx2 v[84:85], v30, s[28:31], 0 offen offset:2560 sc0 sc1
    buffer_load_dwordx2 v[86:87], v30, s[28:31], 0 offen offset:2816 sc0 sc1
    buffer_load_dwordx2 v[88:89], v30, s[28:31], 0 offen offset:3072 sc0 sc1
    buffer_load_dwordx2 v[90:91], v30, s[28:31], 0 offen offset:3328 sc0 sc1
    buffer_load_dwordx2 v[92:93], v30, s[28:31], 0 offen offset:3584 sc0 sc1
    v_mov_b32 v7, 1
    s_waitcnt vmcnt(0)
    s_cmp_le_u32 s40, 0
    s_cbranch_scc1 K1_CHKDONE
    v_and_b32 v7, v7, v64
    s_cmp_le_u32 s40, 1
    s_cbranch_scc1 K1_CHKDONE
    v_and_b32 v7, v7, v66
    s_cmp_le_u32 s40, 2
    s_cbranch_scc1 K1_CHKDONE
    v_and_b32 v7, v7, v68
    s_cmp_le_u32 s40, 3
    s_cbranch_scc1 K1_CHKDONE
    v_and_b32 v7, v7, v70
    s_cmp_le_u32 s40, 4
    s_cbranch_scc1 K1_CHKDONE
    v_and_b32 v7, v7, v72
    s_cmp_le_u32 s40, 5
    s_cbranch_scc1 K1_CHKDONE
    v_and_b32 v7, v7, v74
    s_cmp_le_u32 s40, 6
    s_cbranch_scc1 K1_CHKDONE
    v_and_b32 v7, v7, v76
    s_cmp_le_u32 s40, 7
    s_cbranch_scc1 K1_CHKDONE
    v_and_b32 v7, v7, v78
    s_cmp_le_u32 s40, 8
    s_cbranch_scc1 K1_CHKDONE
    v_and_b32 v7, v7, v80
    s_cmp_le_u32 s40, 9
    s_cbranch_scc1 K1_CHKDONE
    v_and_b32 v7, v7, v82
    s_cmp_le_u32 s40, 10
    s_cbranch_scc1 K1_CHKDONE
    v_and_b32 v7, v7, v84
    s_cmp_le_u32 s40, 11
    s_cbranch_scc1 K1_CHKDONE
    v_and_b32 v7, v7, v86
    s_cmp_le_u32 s40, 12
    s_cbranch_scc1 K1_CHKDONE
    v_and_b32 v7, v7, v88
    s_cmp_le_u32 s40, 13
    s_cbranch_scc1 K1_CHKDONE
    v_and_b32 v7, v7, v90
    s_cmp_le_u32 s40, 14
    s_cbranch_scc1 K1_CHKDONE
    v_and_b32 v7, v7, v92
K1_CHKDONE:
    s_nop 1
    v_cmp_eq_u32 s[6:7], 1, v7
    s_nop 1
    s_cmp_eq_u64 s[6:7], -1
    s_cbranch_scc1 K1_POLLDONE
    s_sleep 2
    s_branch K1_POLL
K1_POLLDONE:
    s_nop 1
    s_cmp_le_u32 s40, 0
    s_cbranch_scc1 K1_CARRYDONE
    v_fma_f32 v64, v16, v28, v64
    v_fma_f32 v65, v16, v29, v65
    v_fma_f32 v64, -v17, v29, v64
    v_fma_f32 v65, v17, v28, v65
    v_mov_b32 v28, v64
    v_mov_b32 v29, v65
    s_cmp_le_u32 s40, 1
    s_cbranch_scc1 K1_CARRYDONE
    v_fma_f32 v66, v16, v28, v66
    v_fma_f32 v67, v16, v29, v67
    v_fma_f32 v66, -v17, v29, v66
    v_fma_f32 v67, v17, v28, v67
    v_mov_b32 v28, v66
    v_mov_b32 v29, v67
    s_cmp_le_u32 s40, 2
    s_cbranch_scc1 K1_CARRYDONE
    v_fma_f32 v68, v16, v28, v68
    v_fma_f32 v69, v16, v29, v69
    v_fma_f32 v68, -v17, v29, v68
    v_fma_f32 v69, v17, v28, v69
    v_mov_b32 v28, v68
    v_mov_b32 v29, v69
    s_cmp_le_u32 s40, 3
    s_cbranch_scc1 K1_CARRYDONE
    v_fma_f32 v70, v16, v28, v70
    v_fma_f32 v71, v16, v29, v71
    v_fma_f32 v70, -v17, v29, v70
    v_fma_f32 v71, v17, v28, v71
    v_mov_b32 v28, v70
    v_mov_b32 v29, v71
    s_cmp_le_u32 s40, 4
    s_cbranch_scc1 K1_CARRYDONE
    v_fma_f32 v72, v16, v28, v72
    v_fma_f32 v73, v16, v29, v73
    v_fma_f32 v72, -v17, v29, v72
    v_fma_f32 v73, v17, v28, v73
    v_mov_b32 v28, v72
    v_mov_b32 v29, v73
    s_cmp_le_u32 s40, 5
    s_cbranch_scc1 K1_CARRYDONE
    v_fma_f32 v74, v16, v28, v74
    v_fma_f32 v75, v16, v29, v75
    v_fma_f32 v74, -v17, v29, v74
    v_fma_f32 v75, v17, v28, v75
    v_mov_b32 v28, v74
    v_mov_b32 v29, v75
    s_cmp_le_u32 s40, 6
    s_cbranch_scc1 K1_CARRYDONE
    v_fma_f32 v76, v16, v28, v76
    v_fma_f32 v77, v16, v29, v77
    v_fma_f32 v76, -v17, v29, v76
    v_fma_f32 v77, v17, v28, v77
    v_mov_b32 v28, v76
    v_mov_b32 v29, v77
    s_cmp_le_u32 s40, 7
    s_cbranch_scc1 K1_CARRYDONE
    v_fma_f32 v78, v16, v28, v78
    v_fma_f32 v79, v16, v29, v79
    v_fma_f32 v78, -v17, v29, v78
    v_fma_f32 v79, v17, v28, v79
    v_mov_b32 v28, v78
    v_mov_b32 v29, v79
    s_cmp_le_u32 s40, 8
    s_cbranch_scc1 K1_CARRYDONE
    v_fma_f32 v80, v16, v28, v80
    v_fma_f32 v81, v16, v29, v81
    v_fma_f32 v80, -v17, v29, v80
    v_fma_f32 v81, v17, v28, v81
    v_mov_b32 v28, v80
    v_mov_b32 v29, v81
    s_cmp_le_u32 s40, 9
    s_cbranch_scc1 K1_CARRYDONE
    v_fma_f32 v82, v16, v28, v82
    v_fma_f32 v83, v16, v29, v83
    v_fma_f32 v82, -v17, v29, v82
    v_fma_f32 v83, v17, v28, v83
    v_mov_b32 v28, v82
    v_mov_b32 v29, v83
    s_cmp_le_u32 s40, 10
    s_cbranch_scc1 K1_CARRYDONE
    v_fma_f32 v84, v16, v28, v84
    v_fma_f32 v85, v16, v29, v85
    v_fma_f32 v84, -v17, v29, v84
    v_fma_f32 v85, v17, v28, v85
    v_mov_b32 v28, v84
    v_mov_b32 v29, v85
    s_cmp_le_u32 s40, 11
    s_cbranch_scc1 K1_CARRYDONE
    v_fma_f32 v86, v16, v28, v86
    v_fma_f32 v87, v16, v29, v87
    v_fma_f32 v86, -v17, v29, v86
    v_fma_f32 v87, v17, v28, v87
    v_mov_b32 v28, v86
    v_mov_b32 v29, v87
    s_cmp_le_u32 s40, 12
    s_cbranch_scc1 K1_CARRYDONE
    v_fma_f32 v88, v16, v28, v88
    v_fma_f32 v89, v16, v29, v89
    v_fma_f32 v88, -v17, v29, v88
    v_fma_f32 v89, v17, v28, v89
    v_mov_b32 v28, v88
    v_mov_b32 v29, v89
    s_cmp_le_u32 s40, 13
    s_cbranch_scc1 K1_CARRYDONE
    v_fma_f32 v90, v16, v28, v90
    v_fma_f32 v91, v16, v29, v91
    v_fma_f32 v90, -v17, v29, v90
    v_fma_f32 v91, v17, v28, v91
    v_mov_b32 v28, v90
    v_mov_b32 v29, v91
    s_cmp_le_u32 s40, 14
    s_cbranch_scc1 K1_CARRYDONE
    v_fma_f32 v92, v16, v28, v92
    v_fma_f32 v93, v16, v29, v93
    v_fma_f32 v92, -v17, v29, v92
    v_fma_f32 v93, v17, v28, v93
    v_mov_b32 v28, v92
    v_mov_b32 v29, v93
K1_CARRYDONE:
    s_nop 1
    v_fma_f32 v24, v26, v28, v24
    v_fma_f32 v25, v26, v29, v25
    v_fma_f32 v24, -v27, v29, v24
    v_fma_f32 v25, v27, v28, v25
    v_mul_f32 v26, v12, v24
    v_mul_f32 v27, v12, v25
    v_fma_f32 v26, -v13, v25, v26
    v_fma_f32 v27, v13, v24, v27
    s_waitcnt vmcnt(0)
    s_cmp_ge_u32 s56, 448
    s_cbranch_scc1 K1_JOBC2
    v_lshrrev_b32 v28, 4, v1
    v_bfe_u32 v29, v1, 2, 2
    v_lshl_add_u32 v28, v28, 3, v29
    v_lshlrev_b32 v28, 7, v28
    v_and_b32 v29, 3, v1
    v_lshl_add_u32 v28, v29, 3, v28
    v_add_u32 v28, s57, v28
    ds_read_b64_tr_b16 v[64:65], v28 offset:0
    ds_read_b64_tr_b16 v[66:67], v28 offset:512
    ds_read_b64_tr_b16 v[68:69], v28 offset:32
    ds_read_b64_tr_b16 v[70:71], v28 offset:544
    ds_read_b64_tr_b16 v[72:73], v28 offset:64
    ds_read_b64_tr_b16 v[74:75], v28 offset:576
    ds_read_b64_tr_b16 v[76:77], v28 offset:96
    ds_read_b64_tr_b16 v[78:79], v28 offset:608
    s_waitcnt lgkmcnt(6)
    buffer_store_dwordx4 v[64:67], v6, s[8:11], s58 offen offset:0
    s_waitcnt lgkmcnt(4)
    buffer_store_dwordx4 v[68:71], v6, s[8:11], s58 offen offset:1024
    s_waitcnt lgkmcnt(2)
    buffer_store_dwordx4 v[72:75], v6, s[8:11], s58 offen offset:2048
    s_waitcnt lgkmcnt(0)
    buffer_store_dwordx4 v[76:79], v6, s[8:11], s58 offen offset:3072
    s_branch K1_JOBDONE
K1_JOBC2:
    s_nop 1
    s_cmp_ge_u32 s56, 960
    s_cbranch_scc1 K1_JOBDONE
    v_add_u32 v28, s57, v6
    ds_read_b128 v[64:67], v28
    ds_read_b128 v[68:71], v28 offset:1024
    s_waitcnt lgkmcnt(0)
    buffer_store_dwordx4 v[64:67], v6, s[8:11], s58 offen
    buffer_store_dwordx4 v[68:71], v6, s[8:11], s58 offen offset:1024
K1_JOBDONE:
    s_nop 1
    v_mul_f32 v24, v10, v26
    v_mul_f32 v25, v10, v27
    v_fma_f32 v24, -v11, v27, v24
    v_fma_f32 v25, v11, v26, v25
    v_add_f32 v32, v32, v24
    v_sub_f32 v48, v48, v25
    v_cndmask_b32 v28, v48, v32, vcc
    s_nop 1
    v_mov_b32_dpp v29, v28 quad_perm:[1,0,3,2] row_mask:0xf bank_mask:0xf
    v_cndmask_b32 v28, v32, v29, vcc
    v_cndmask_b32 v29, v29, v48, vcc
    v_cvt_pk_bf16_f32 v32, v28, v29
    buffer_store_dword v32, v2, s[8:11], 0 offen offset:0
    v_mul_f32 v26, v10, v24
    v_mul_f32 v27, v10, v25
    v_fma_f32 v26, -v11, v25, v26
    v_fma_f32 v27, v11, v24, v27
    v_add_f32 v33, v33, v26
    v_sub_f32 v49, v49, v27
    v_cndmask_b32 v28, v49, v33, vcc
    s_nop 1
    v_mov_b32_dpp v29, v28 quad_perm:[1,0,3,2] row_mask:0xf bank_mask:0xf
    v_cndmask_b32 v28, v33, v29, vcc
    v_cndmask_b32 v29, v29, v49, vcc
    v_cvt_pk_bf16_f32 v33, v28, v29
    buffer_store_dword v33, v2, s[8:11], 0 offen offset:16
    v_mul_f32 v24, v10, v26
    v_mul_f32 v25, v10, v27
    v_fma_f32 v24, -v11, v27, v24
    v_fma_f32 v25, v11, v26, v25
    v_add_f32 v34, v34, v24
    v_sub_f32 v50, v50, v25
    v_cndmask_b32 v28, v50, v34, vcc
    s_nop 1
    v_mov_b32_dpp v29, v28 quad_perm:[1,0,3,2] row_mask:0xf bank_mask:0xf
    v_cndmask_b32 v28, v34, v29, vcc
    v_cndmask_b32 v29, v29, v50, vcc
    v_cvt_pk_bf16_f32 v34, v28, v29
    buffer_store_dword v34, v2, s[8:11], 0 offen offset:32
    v_mul_f32 v26, v10, v24
    v_mul_f32 v27, v10, v25
    v_fma_f32 v26, -v11, v25, v26
    v_fma_f32 v27, v11, v24, v27
    v_add_f32 v35, v35, v26
    v_sub_f32 v51, v51, v27
    v_cndmask_b32 v28, v51, v35, vcc
    s_nop 1
    v_mov_b32_dpp v29, v28 quad_perm:[1,0,3,2] row_mask:0xf bank_mask:0xf
    v_cndmask_b32 v28, v35, v29, vcc
    v_cndmask_b32 v29, v29, v51, vcc
    v_cvt_pk_bf16_f32 v35, v28, v29
    buffer_store_dword v35, v2, s[8:11], 0 offen offset:48
    v_mul_f32 v24, v10, v26
    v_mul_f32 v25, v10, v27
    v_fma_f32 v24, -v11, v27, v24
    v_fma_f32 v25, v11, v26, v25
    v_add_f32 v36, v36, v24
    v_sub_f32 v52, v52, v25
    v_cndmask_b32 v28, v52, v36, vcc
    s_nop 1
    v_mov_b32_dpp v29, v28 quad_perm:[1,0,3,2] row_mask:0xf bank_mask:0xf
    v_cndmask_b32 v28, v36, v29, vcc
    v_cndmask_b32 v29, v29, v52, vcc
    v_cvt_pk_bf16_f32 v36, v28, v29
    buffer_store_dword v36, v2, s[8:11], 0 offen offset:64
    v_mul_f32 v26, v10, v24
    v_mul_f32 v27, v10, v25
    v_fma_f32 v26, -v11, v25, v26
    v_fma_f32 v27, v11, v24, v27
    v_add_f32 v37, v37, v26
    v_sub_f32 v53, v53, v27
    v_cndmask_b32 v28, v53, v37, vcc
    s_nop 1
    v_mov_b32_dpp v29, v28 quad_perm:[1,0,3,2] row_mask:0xf bank_mask:0xf
    v_cndmask_b32 v28, v37, v29, vcc
    v_cndmask_b32 v29, v29, v53, vcc
    v_cvt_pk_bf16_f32 v37, v28, v29
    buffer_store_dword v37, v2, s[8:11], 0 offen offset:80
    v_mul_f32 v24, v10, v26
    v_mul_f32 v25, v10, v27
    v_fma_f32 v24, -v11, v27, v24
    v_fma_f32 v25, v11, v26, v25
    v_add_f32 v38, v38, v24
    v_sub_f32 v54, v54, v25
    v_cndmask_b32 v28, v54, v38, vcc
    s_nop 1
    v_mov_b32_dpp v29, v28 quad_perm:[1,0,3,2] row_mask:0xf bank_mask:0xf
    v_cndmask_b32 v28, v38, v29, vcc
    v_cndmask_b32 v29, v29, v54, vcc
    v_cvt_pk_bf16_f32 v38, v28, v29
    buffer_store_dword v38, v2, s[8:11], 0 offen offset:96
    v_mul_f32 v26, v10, v24
    v_mul_f32 v27, v10, v25
    v_fma_f32 v26, -v11, v25, v26
    v_fma_f32 v27, v11, v24, v27
    v_add_f32 v39, v39, v26
    v_sub_f32 v55, v55, v27
    v_cndmask_b32 v28, v55, v39, vcc
    s_nop 1
    v_mov_b32_dpp v29, v28 quad_perm:[1,0,3,2] row_mask:0xf bank_mask:0xf
    v_cndmask_b32 v28, v39, v29, vcc
    v_cndmask_b32 v29, v29, v55, vcc
    v_cvt_pk_bf16_f32 v39, v28, v29
    buffer_store_dword v39, v2, s[8:11], 0 offen offset:112
    v_mul_f32 v24, v10, v26
    v_mul_f32 v25, v10, v27
    v_fma_f32 v24, -v11, v27, v24
    v_fma_f32 v25, v11, v26, v25
    v_add_f32 v40, v40, v24
    v_sub_f32 v56, v56, v25
    v_cndmask_b32 v28, v56, v40, vcc
    s_nop 1
    v_mov_b32_dpp v29, v28 quad_perm:[1,0,3,2] row_mask:0xf bank_mask:0xf
    v_cndmask_b32 v28, v40, v29, vcc
    v_cndmask_b32 v29, v29, v56, vcc
    v_cvt_pk_bf16_f32 v40, v28, v29
    buffer_store_dword v40, v2, s[8:11], 0 offen offset:128
    v_mul_f32 v26, v10, v24
    v_mul_f32 v27, v10, v25
    v_fma_f32 v26, -v11, v25, v26
    v_fma_f32 v27, v11, v24, v27
    v_add_f32 v41, v41, v26
    v_sub_f32 v57, v57, v27
    v_cndmask_b32 v28, v57, v41, vcc
    s_nop 1
    v_mov_b32_dpp v29, v28 quad_perm:[1,0,3,2] row_mask:0xf bank_mask:0xf
    v_cndmask_b32 v28, v41, v29, vcc
    v_cndmask_b32 v29, v29, v57, vcc
    v_cvt_pk_bf16_f32 v41, v28, v29
    buffer_store_dword v41, v2, s[8:11], 0 offen offset:144
    v_mul_f32 v24, v10, v26
    v_mul_f32 v25, v10, v27
    v_fma_f32 v24, -v11, v27, v24
    v_fma_f32 v25, v11, v26, v25
    v_add_f32 v42, v42, v24
    v_sub_f32 v58, v58, v25
    v_cndmask_b32 v28, v58, v42, vcc
    s_nop 1
    v_mov_b32_dpp v29, v28 quad_perm:[1,0,3,2] row_mask:0xf bank_mask:0xf
    v_cndmask_b32 v28, v42, v29, vcc
    v_cndmask_b32 v29, v29, v58, vcc
    v_cvt_pk_bf16_f32 v42, v28, v29
    buffer_store_dword v42, v2, s[8:11], 0 offen offset:160
    v_mul_f32 v26, v10, v24
    v_mul_f32 v27, v10, v25
    v_fma_f32 v26, -v11, v25, v26
    v_fma_f32 v27, v11, v24, v27
    v_add_f32 v43, v43, v26
    v_sub_f32 v59, v59, v27
    v_cndmask_b32 v28, v59, v43, vcc
    s_nop 1
    v_mov_b32_dpp v29, v28 quad_perm:[1,0,3,2] row_mask:0xf bank_mask:0xf
    v_cndmask_b32 v28, v43, v29, vcc
    v_cndmask_b32 v29, v29, v59, vcc
    v_cvt_pk_bf16_f32 v43, v28, v29
    buffer_store_dword v43, v2, s[8:11], 0 offen offset:176
    v_mul_f32 v24, v10, v26
    v_mul_f32 v25, v10, v27
    v_fma_f32 v24, -v11, v27, v24
    v_fma_f32 v25, v11, v26, v25
    v_add_f32 v44, v44, v24
    v_sub_f32 v60, v60, v25
    v_cndmask_b32 v28, v60, v44, vcc
    s_nop 1
    v_mov_b32_dpp v29, v28 quad_perm:[1,0,3,2] row_mask:0xf bank_mask:0xf
    v_cndmask_b32 v28, v44, v29, vcc
    v_cndmask_b32 v29, v29, v60, vcc
    v_cvt_pk_bf16_f32 v44, v28, v29
    buffer_store_dword v44, v2, s[8:11], 0 offen offset:192
    v_mul_f32 v26, v10, v24
    v_mul_f32 v27, v10, v25
    v_fma_f32 v26, -v11, v25, v26
    v_fma_f32 v27, v11, v24, v27
    v_add_f32 v45, v45, v26
    v_sub_f32 v61, v61, v27
    v_cndmask_b32 v28, v61, v45, vcc
    s_nop 1
    v_mov_b32_dpp v29, v28 quad_perm:[1,0,3,2] row_mask:0xf bank_mask:0xf
    v_cndmask_b32 v28, v45, v29, vcc
    v_cndmask_b32 v29, v29, v61, vcc
    v_cvt_pk_bf16_f32 v45, v28, v29
    buffer_store_dword v45, v2, s[8:11], 0 offen offset:208
    v_mul_f32 v24, v10, v26
    v_mul_f32 v25, v10, v27
    v_fma_f32 v24, -v11, v27, v24
    v_fma_f32 v25, v11, v26, v25
    v_add_f32 v46, v46, v24
    v_sub_f32 v62, v62, v25
    v_cndmask_b32 v28, v62, v46, vcc
    s_nop 1
    v_mov_b32_dpp v29, v28 quad_perm:[1,0,3,2] row_mask:0xf bank_mask:0xf
    v_cndmask_b32 v28, v46, v29, vcc
    v_cndmask_b32 v29, v29, v62, vcc
    v_cvt_pk_bf16_f32 v46, v28, v29
    buffer_store_dword v46, v2, s[8:11], 0 offen offset:224
    v_mul_f32 v26, v10, v24
    v_mul_f32 v27, v10, v25
    v_fma_f32 v26, -v11, v25, v26
    v_fma_f32 v27, v11, v24, v27
    v_add_f32 v47, v47, v26
    v_sub_f32 v63, v63, v27
    v_cndmask_b32 v28, v63, v47, vcc
    s_nop 1
    v_mov_b32_dpp v29, v28 quad_perm:[1,0,3,2] row_mask:0xf bank_mask:0xf
    v_cndmask_b32 v28, v47, v29, vcc
    v_cndmask_b32 v29, v29, v63, vcc
    v_cvt_pk_bf16_f32 v47, v28, v29
    buffer_store_dword v47, v2, s[8:11], 0 offen offset:240
    s_endpgm
K1_COMPUTE:
    s_nop 3
    s_setprio 3
    s_sub_u32 s42, s42, 4
    s_lshl_b32 s3, s40, 2
    s_add_u32 s3, s3, s42
    s_lshl_b32 s3, s3, 15
    s_add_u32 s4, s3, 0
    buffer_load_dwordx4 a[32:35], v6, s[8:11], s4 offen offset:0
    buffer_load_dwordx4 a[36:39], v6, s[8:11], s4 offen offset:1024
    buffer_load_dwordx4 a[40:43], v6, s[8:11], s4 offen offset:2048
    buffer_load_dwordx4 a[44:47], v6, s[8:11], s4 offen offset:3072
    s_add_u32 s4, s3, 4096
    buffer_load_dwordx4 a[48:51], v6, s[8:11], s4 offen offset:0
    buffer_load_dwordx4 a[52:55], v6, s[8:11], s4 offen offset:1024
    buffer_load_dwordx4 a[56:59], v6, s[8:11], s4 offen offset:2048
    buffer_load_dwordx4 a[60:63], v6, s[8:11], s4 offen offset:3072
    s_add_u32 s4, s3, 8192
    buffer_load_dwordx4 a[64:67], v6, s[8:11], s4 offen offset:0
    buffer_load_dwordx4 a[68:71], v6, s[8:11], s4 offen offset:1024
    buffer_load_dwordx4 a[72:75], v6, s[8:11], s4 offen offset:2048
    buffer_load_dwordx4 a[76:79], v6, s[8:11], s4 offen offset:3072
    s_add_u32 s4, s3, 12288
    buffer_load_dwordx4 a[80:83], v6, s[8:11], s4 offen offset:0
    buffer_load_dwordx4 a[84:87], v6, s[8:11], s4 offen offset:1024
    buffer_load_dwordx4 a[88:91], v6, s[8:11], s4 offen offset:2048
    buffer_load_dwordx4 a[92:95], v6, s[8:11], s4 offen offset:3072
    s_add_u32 s4, s3, 16384
    buffer_load_dwordx4 a[96:99], v6, s[8:11], s4 offen offset:0
    buffer_load_dwordx4 a[100:103], v6, s[8:11], s4 offen offset:1024
    buffer_load_dwordx4 a[104:107], v6, s[8:11], s4 offen offset:2048
    buffer_load_dwordx4 a[108:111], v6, s[8:11], s4 offen offset:3072
    s_add_u32 s4, s3, 20480
    buffer_load_dwordx4 a[112:115], v6, s[8:11], s4 offen offset:0
    buffer_load_dwordx4 a[116:119], v6, s[8:11], s4 offen offset:1024
    buffer_load_dwordx4 a[120:123], v6, s[8:11], s4 offen offset:2048
    buffer_load_dwordx4 a[124:127], v6, s[8:11], s4 offen offset:3072
    s_add_u32 s4, s3, 24576
    buffer_load_dwordx4 a[128:131], v6, s[8:11], s4 offen offset:0
    buffer_load_dwordx4 a[132:135], v6, s[8:11], s4 offen offset:1024
    buffer_load_dwordx4 a[136:139], v6, s[8:11], s4 offen offset:2048
    buffer_load_dwordx4 a[140:143], v6, s[8:11], s4 offen offset:3072
    s_add_u32 s4, s3, 28672
    buffer_load_dwordx4 a[144:147], v6, s[8:11], s4 offen offset:0
    buffer_load_dwordx4 a[148:151], v6, s[8:11], s4 offen offset:1024
    buffer_load_dwordx4 a[152:155], v6, s[8:11], s4 offen offset:2048
    buffer_load_dwordx4 a[156:159], v6, s[8:11], s4 offen offset:3072
    v_add_u32 v5, 0x10000, v6
    s_lshl_b32 s3, s42, 5
    v_add_u32 v7, s3, v3
    v_mul_u32_u24 v7, 272, v7
    v_lshl_add_u32 v7, v4, 4, v7
    v_add_u32 v7, 98304, v7
    s_lshl_b32 s3, s40, 1
    s_lshr_b32 s4, s42, 1
    s_add_u32 s3, s3, s4
    s_mul_i32 s3, s3, 88
    s_add_u32 s3, s3, 32
    s_lshl_b32 s3, s3, 12
    s_and_b32 s4, s42, 1
    s_lshl_b32 s4, s4, 11
    s_add_u32 s3, s3, s4
    s_add_u32 s3, s3, 10485760
    v_lshrrev_b32 v2, 4, v3
    v_lshlrev_b32 v2, 10, v2
    v_and_b32 v8, 15, v3
    v_lshl_add_u32 v2, v8, 4, v2
    v_add_u32 v2, s3, v2
    s_mul_i32 s46, s41, 14
    v_add_u32 v8, s46, v4
    v_bfe_u32 v9, v3, 1, 3
    v_lshlrev_b32 v10, 10, v3
    v_add_u32 v11, 0, v4
    v_xor_b32 v11, v11, v9
    v_lshl_add_u32 v11, v11, 4, v10
    v_add_u32 v84, 65536, v11
    v_add_u32 v88, 0, v11
    v_add_u32 v11, 2, v4
    v_xor_b32 v11, v11, v9
    v_lshl_add_u32 v11, v11, 4, v10
    v_add_u32 v85, 65536, v11
    v_add_u32 v89, 0, v11
    v_add_u32 v11, 4, v4
    v_xor_b32 v11, v11, v9
    v_lshl_add_u32 v11, v11, 4, v10
    v_add_u32 v86, 65536, v11
    v_add_u32 v90, 0, v11
    v_add_u32 v11, 6, v4
    v_xor_b32 v11, v11, v9
    v_lshl_add_u32 v11, v11, 4, v10
    v_add_u32 v87, 65536, v11
    v_add_u32 v91, 0, v11
    s_barrier
    ds_read_b128 a[0:3], v6 offset:0
    ds_read_b128 a[4:7], v6 offset:32768
    ds_read_b128 a[8:11], v6 offset:1024
    ds_read_b128 a[12:15], v6 offset:33792
    ds_read_b128 a[16:19], v6 offset:2048
    s_waitcnt vmcnt(31)
    s_waitcnt lgkmcnt(4)
    v_mfma_f32_32x32x16_bf16 v[32:47], a[0:3], a[32:35], 0
    ds_read_b128 a[20:23], v6 offset:34816
    s_waitcnt lgkmcnt(4)
    v_mfma_f32_32x32x16_bf16 v[48:63], a[4:7], a[32:35], 0
    ds_read_b128 a[24:27], v6 offset:3072
    s_waitcnt vmcnt(30)
    s_waitcnt lgkmcnt(4)
    v_mfma_f32_32x32x16_bf16 v[32:47], a[8:11], a[36:39], v[32:47]
    ds_read_b128 a[28:31], v6 offset:35840
    s_waitcnt lgkmcnt(4)
    v_mfma_f32_32x32x16_bf16 v[48:63], a[12:15], a[36:39], v[48:63]
    ds_read_b128 a[0:3], v6 offset:4096
    s_waitcnt vmcnt(29)
    s_waitcnt lgkmcnt(4)
    v_mfma_f32_32x32x16_bf16 v[32:47], a[16:19], a[40:43], v[32:47]
    ds_read_b128 a[4:7], v6 offset:36864
    s_waitcnt lgkmcnt(4)
    v_mfma_f32_32x32x16_bf16 v[48:63], a[20:23], a[40:43], v[48:63]
    ds_read_b128 a[8:11], v6 offset:5120
    s_waitcnt vmcnt(28)
    s_waitcnt lgkmcnt(4)
    v_mfma_f32_32x32x16_bf16 v[32:47], a[24:27], a[44:47], v[32:47]
    ds_read_b128 a[12:15], v6 offset:37888
    s_waitcnt lgkmcnt(4)
    v_mfma_f32_32x32x16_bf16 v[48:63], a[28:31], a[44:47], v[48:63]
    ds_read_b128 a[16:19], v6 offset:6144
    s_waitcnt vmcnt(27)
    s_waitcnt lgkmcnt(4)
    v_mfma_f32_32x32x16_bf16 v[32:47], a[0:3], a[48:51], v[32:47]
    ds_read_b128 a[20:23], v6 offset:38912
    s_waitcnt lgkmcnt(4)
    v_mfma_f32_32x32x16_bf16 v[48:63], a[4:7], a[48:51], v[48:63]
    ds_read_b128 a[24:27], v6 offset:7168
    s_waitcnt vmcnt(26)
    s_waitcnt lgkmcnt(4)
    v_mfma_f32_32x32x16_bf16 v[32:47], a[8:11], a[52:55], v[32:47]
    ds_read_b128 a[28:31], v6 offset:39936
    s_waitcnt lgkmcnt(4)
    v_mfma_f32_32x32x16_bf16 v[48:63], a[12:15], a[52:55], v[48:63]
    ds_read_b128 a[0:3], v6 offset:8192
    s_waitcnt vmcnt(25)
    s_waitcnt lgkmcnt(4)
    v_mfma_f32_32x32x16_bf16 v[32:47], a[16:19], a[56:59], v[32:47]
    ds_read_b128 a[4:7], v6 offset:40960
    s_waitcnt lgkmcnt(4)
    v_mfma_f32_32x32x16_bf16 v[48:63], a[20:23], a[56:59], v[48:63]
    ds_read_b128 a[8:11], v6 offset:9216
    s_waitcnt vmcnt(24)
    s_waitcnt lgkmcnt(4)
    v_mfma_f32_32x32x16_bf16 v[32:47], a[24:27], a[60:63], v[32:47]
    ds_read_b128 a[12:15], v6 offset:41984
    s_waitcnt lgkmcnt(4)
    v_mfma_f32_32x32x16_bf16 v[48:63], a[28:31], a[60:63], v[48:63]
    ds_read_b128 a[16:19], v6 offset:10240
    s_waitcnt vmcnt(23)
    s_waitcnt lgkmcnt(4)
    v_mfma_f32_32x32x16_bf16 v[32:47], a[0:3], a[64:67], v[32:47]
    ds_read_b128 a[20:23], v6 offset:43008
    s_waitcnt lgkmcnt(4)
    v_mfma_f32_32x32x16_bf16 v[48:63], a[4:7], a[64:67], v[48:63]
    ds_read_b128 a[24:27], v6 offset:11264
    s_waitcnt vmcnt(22)
    s_waitcnt lgkmcnt(4)
    v_mfma_f32_32x32x16_bf16 v[32:47], a[8:11], a[68:71], v[32:47]
    ds_read_b128 a[28:31], v6 offset:44032
    s_waitcnt lgkmcnt(4)
    v_mfma_f32_32x32x16_bf16 v[48:63], a[12:15], a[68:71], v[48:63]
    ds_read_b128 a[0:3], v6 offset:12288
    s_waitcnt vmcnt(21)
    s_waitcnt lgkmcnt(4)
    v_mfma_f32_32x32x16_bf16 v[32:47], a[16:19], a[72:75], v[32:47]
    ds_read_b128 a[4:7], v6 offset:45056
    s_waitcnt lgkmcnt(4)
    v_mfma_f32_32x32x16_bf16 v[48:63], a[20:23], a[72:75], v[48:63]
    ds_read_b128 a[8:11], v6 offset:13312
    s_waitcnt vmcnt(20)
    s_waitcnt lgkmcnt(4)
    v_mfma_f32_32x32x16_bf16 v[32:47], a[24:27], a[76:79], v[32:47]
    ds_read_b128 a[12:15], v6 offset:46080
    s_waitcnt lgkmcnt(4)
    v_mfma_f32_32x32x16_bf16 v[48:63], a[28:31], a[76:79], v[48:63]
    ds_read_b128 a[16:19], v6 offset:14336
    s_waitcnt vmcnt(19)
    s_waitcnt lgkmcnt(4)
    v_mfma_f32_32x32x16_bf16 v[32:47], a[0:3], a[80:83], v[32:47]
    ds_read_b128 a[20:23], v6 offset:47104
    s_waitcnt lgkmcnt(4)
    v_mfma_f32_32x32x16_bf16 v[48:63], a[4:7], a[80:83], v[48:63]
    ds_read_b128 a[24:27], v6 offset:15360
    s_waitcnt vmcnt(18)
    s_waitcnt lgkmcnt(4)
    v_mfma_f32_32x32x16_bf16 v[32:47], a[8:11], a[84:87], v[32:47]
    ds_read_b128 a[28:31], v6 offset:48128
    s_waitcnt lgkmcnt(4)
    v_mfma_f32_32x32x16_bf16 v[48:63], a[12:15], a[84:87], v[48:63]
    ds_read_b128 a[0:3], v6 offset:16384
    s_waitcnt vmcnt(17)
    s_waitcnt lgkmcnt(4)
    v_mfma_f32_32x32x16_bf16 v[32:47], a[16:19], a[88:91], v[32:47]
    ds_read_b128 a[4:7], v6 offset:49152
    s_waitcnt lgkmcnt(4)
    v_mfma_f32_32x32x16_bf16 v[48:63], a[20:23], a[88:91], v[48:63]
    ds_read_b128 a[8:11], v6 offset:17408
    s_waitcnt vmcnt(16)
    s_waitcnt lgkmcnt(4)
    v_mfma_f32_32x32x16_bf16 v[32:47], a[24:27], a[92:95], v[32:47]
    ds_read_b128 a[12:15], v6 offset:50176
    s_waitcnt lgkmcnt(4)
    v_mfma_f32_32x32x16_bf16 v[48:63], a[28:31], a[92:95], v[48:63]
    ds_read_b128 a[16:19], v6 offset:18432
    s_waitcnt vmcnt(15)
    s_waitcnt lgkmcnt(4)
    v_mfma_f32_32x32x16_bf16 v[32:47], a[0:3], a[96:99], v[32:47]
    ds_read_b128 a[20:23], v6 offset:51200
    s_waitcnt lgkmcnt(4)
    v_mfma_f32_32x32x16_bf16 v[48:63], a[4:7], a[96:99], v[48:63]
    ds_read_b128 a[24:27], v6 offset:19456
    s_waitcnt vmcnt(14)
    s_waitcnt lgkmcnt(4)
    v_mfma_f32_32x32x16_bf16 v[32:47], a[8:11], a[100:103], v[32:47]
    ds_read_b128 a[28:31], v6 offset:52224
    s_waitcnt lgkmcnt(4)
    v_mfma_f32_32x32x16_bf16 v[48:63], a[12:15], a[100:103], v[48:63]
    ds_read_b128 a[0:3], v6 offset:20480
    s_waitcnt vmcnt(13)
    s_waitcnt lgkmcnt(4)
    v_mfma_f32_32x32x16_bf16 v[32:47], a[16:19], a[104:107], v[32:47]
    ds_read_b128 a[4:7], v6 offset:53248
    s_waitcnt lgkmcnt(4)
    v_mfma_f32_32x32x16_bf16 v[48:63], a[20:23], a[104:107], v[48:63]
    ds_read_b128 a[8:11], v6 offset:21504
    s_waitcnt vmcnt(12)
    s_waitcnt lgkmcnt(4)
    v_mfma_f32_32x32x16_bf16 v[32:47], a[24:27], a[108:111], v[32:47]
    ds_read_b128 a[12:15], v6 offset:54272
    s_waitcnt lgkmcnt(4)
    v_mfma_f32_32x32x16_bf16 v[48:63], a[28:31], a[108:111], v[48:63]
    ds_read_b128 a[16:19], v6 offset:22528
    s_waitcnt vmcnt(11)
    s_waitcnt lgkmcnt(4)
    v_mfma_f32_32x32x16_bf16 v[32:47], a[0:3], a[112:115], v[32:47]
    ds_read_b128 a[20:23], v6 offset:55296
    s_waitcnt lgkmcnt(4)
    v_mfma_f32_32x32x16_bf16 v[48:63], a[4:7], a[112:115], v[48:63]
    ds_read_b128 a[24:27], v6 offset:23552
    s_waitcnt vmcnt(10)
    s_waitcnt lgkmcnt(4)
    v_mfma_f32_32x32x16_bf16 v[32:47], a[8:11], a[116:119], v[32:47]
    ds_read_b128 a[28:31], v6 offset:56320
    s_waitcnt lgkmcnt(4)
    v_mfma_f32_32x32x16_bf16 v[48:63], a[12:15], a[116:119], v[48:63]
    ds_read_b128 a[0:3], v6 offset:24576
    s_waitcnt vmcnt(9)
    s_waitcnt lgkmcnt(4)
    v_mfma_f32_32x32x16_bf16 v[32:47], a[16:19], a[120:123], v[32:47]
    ds_read_b128 a[4:7], v6 offset:57344
    s_waitcnt lgkmcnt(4)
    v_mfma_f32_32x32x16_bf16 v[48:63], a[20:23], a[120:123], v[48:63]
    ds_read_b128 a[8:11], v6 offset:25600
    s_waitcnt vmcnt(8)
    s_waitcnt lgkmcnt(4)
    v_mfma_f32_32x32x16_bf16 v[32:47], a[24:27], a[124:127], v[32:47]
    ds_read_b128 a[12:15], v6 offset:58368
    s_waitcnt lgkmcnt(4)
    v_mfma_f32_32x32x16_bf16 v[48:63], a[28:31], a[124:127], v[48:63]
    ds_read_b128 a[16:19], v6 offset:26624
    s_waitcnt vmcnt(7)
    s_waitcnt lgkmcnt(4)
    v_mfma_f32_32x32x16_bf16 v[32:47], a[0:3], a[128:131], v[32:47]
    ds_read_b128 a[20:23], v6 offset:59392
    s_waitcnt lgkmcnt(4)
    v_mfma_f32_32x32x16_bf16 v[48:63], a[4:7], a[128:131], v[48:63]
    ds_read_b128 a[24:27], v6 offset:27648
    s_waitcnt vmcnt(6)
    s_waitcnt lgkmcnt(4)
    v_mfma_f32_32x32x16_bf16 v[32:47], a[8:11], a[132:135], v[32:47]
    ds_read_b128 a[28:31], v6 offset:60416
    s_waitcnt lgkmcnt(4)
    v_mfma_f32_32x32x16_bf16 v[48:63], a[12:15], a[132:135], v[48:63]
    ds_read_b128 a[0:3], v6 offset:28672
    s_waitcnt vmcnt(5)
    s_waitcnt lgkmcnt(4)
    v_mfma_f32_32x32x16_bf16 v[32:47], a[16:19], a[136:139], v[32:47]
    ds_read_b128 a[4:7], v6 offset:61440
    s_waitcnt lgkmcnt(4)
    v_mfma_f32_32x32x16_bf16 v[48:63], a[20:23], a[136:139], v[48:63]
    ds_read_b128 a[8:11], v6 offset:29696
    s_waitcnt vmcnt(4)
    s_waitcnt lgkmcnt(4)
    v_mfma_f32_32x32x16_bf16 v[32:47], a[24:27], a[140:143], v[32:47]
    ds_read_b128 a[12:15], v6 offset:62464
    s_waitcnt lgkmcnt(4)
    v_mfma_f32_32x32x16_bf16 v[48:63], a[28:31], a[140:143], v[48:63]
    ds_read_b128 a[16:19], v6 offset:30720
    s_waitcnt vmcnt(3)
    s_waitcnt lgkmcnt(4)
    v_mfma_f32_32x32x16_bf16 v[32:47], a[0:3], a[144:147], v[32:47]
    ds_read_b128 a[20:23], v6 offset:63488
    s_waitcnt lgkmcnt(4)
    v_mfma_f32_32x32x16_bf16 v[48:63], a[4:7], a[144:147], v[48:63]
    ds_read_b128 a[24:27], v6 offset:31744
    s_waitcnt vmcnt(2)
    s_waitcnt lgkmcnt(4)
    v_mfma_f32_32x32x16_bf16 v[32:47], a[8:11], a[148:151], v[32:47]
    ds_read_b128 a[28:31], v6 offset:64512
    s_waitcnt lgkmcnt(4)
    v_mfma_f32_32x32x16_bf16 v[48:63], a[12:15], a[148:151], v[48:63]
    s_barrier
    ds_read_b128 a[0:3], v84 offset:0
    s_waitcnt vmcnt(1)
    s_waitcnt lgkmcnt(4)
    v_mfma_f32_32x32x16_bf16 v[32:47], a[16:19], a[152:155], v[32:47]
    ds_read_b128 a[4:7], v85 offset:0
    s_waitcnt lgkmcnt(4)
    v_mfma_f32_32x32x16_bf16 v[48:63], a[20:23], a[152:155], v[48:63]
    ds_read_b128 a[8:11], v86 offset:0
    s_waitcnt vmcnt(0)
    s_waitcnt lgkmcnt(4)
    v_mfma_f32_32x32x16_bf16 v[32:47], a[24:27], a[156:159], v[32:47]
    ds_read_b128 a[12:15], v87 offset:0
    s_waitcnt lgkmcnt(4)
    v_mfma_f32_32x32x16_bf16 v[48:63], a[28:31], a[156:159], v[48:63]
    ds_read_b128 a[16:19], v84 offset:128
    s_waitcnt lgkmcnt(4)
    v_mfma_f32_32x32x16_bf16 v[16:31], a[0:3], a[32:35], 0
    ds_read_b128 a[20:23], v85 offset:128
    s_waitcnt lgkmcnt(4)
    v_mfma_f32_32x32x16_bf16 v[16:31], a[4:7], a[36:39], v[16:31]
    ds_read_b128 a[24:27], v86 offset:128
    s_waitcnt lgkmcnt(4)
    v_mfma_f32_32x32x16_bf16 v[16:31], a[8:11], a[40:43], v[16:31]
    s_nop 2
    v_cvt_pk_bf16_f32 v72, v48, v49
    v_cvt_pk_bf16_f32 v76, v56, v57
    v_cvt_pk_bf16_f32 v73, v50, v51
    v_cvt_pk_bf16_f32 v77, v58, v59
    v_cvt_pk_bf16_f32 v74, v52, v53
    v_cvt_pk_bf16_f32 v78, v60, v61
    v_cvt_pk_bf16_f32 v75, v54, v55
    ds_read_b128 a[28:31], v87 offset:128
    s_waitcnt lgkmcnt(4)
    v_mfma_f32_32x32x16_bf16 v[16:31], a[12:15], a[44:47], v[16:31]
    v_cvt_pk_bf16_f32 v79, v62, v63
    v_lshlrev_b32 v48, 16, v72
    v_and_b32 v49, 0xffff0000, v72
    v_lshlrev_b32 v50, 16, v73
    v_and_b32 v51, 0xffff0000, v73
    v_lshlrev_b32 v52, 16, v74
    v_and_b32 v53, 0xffff0000, v74
    ds_read_b128 a[0:3], v84 offset:256
    s_waitcnt lgkmcnt(4)
    v_mfma_f32_32x32x16_bf16 v[16:31], a[16:19], a[48:51], v[16:31]
    v_lshlrev_b32 v54, 16, v75
    v_and_b32 v55, 0xffff0000, v75
    v_mul_f32 v48, 0xbfb8aa3b, v48
    v_mul_f32 v49, 0xbfb8aa3b, v49
    v_mul_f32 v50, 0xbfb8aa3b, v50
    v_mul_f32 v51, 0xbfb8aa3b, v51
    v_mul_f32 v52, 0xbfb8aa3b, v52
    ds_read_b128 a[4:7], v85 offset:256
    s_waitcnt lgkmcnt(4)
    v_mfma_f32_32x32x16_bf16 v[16:31], a[20:23], a[52:55], v[16:31]
    v_mul_f32 v53, 0xbfb8aa3b, v53
    v_mul_f32 v54, 0xbfb8aa3b, v54
    v_mul_f32 v55, 0xbfb8aa3b, v55
    v_exp_f32 v48, v48
    v_lshlrev_b32 v56, 16, v76
    v_exp_f32 v49, v49
    v_and_b32 v57, 0xffff0000, v76
    ds_read_b128 a[8:11], v86 offset:256
    s_waitcnt lgkmcnt(4)
    v_mfma_f32_32x32x16_bf16 v[16:31], a[24:27], a[56:59], v[16:31]
    v_exp_f32 v50, v50
    v_lshlrev_b32 v58, 16, v77
    v_exp_f32 v51, v51
    v_and_b32 v59, 0xffff0000, v77
    v_exp_f32 v52, v52
    v_lshlrev_b32 v60, 16, v78
    v_exp_f32 v53, v53
    ds_read_b128 a[12:15], v87 offset:256
    s_waitcnt lgkmcnt(4)
    v_mfma_f32_32x32x16_bf16 v[16:31], a[28:31], a[60:63], v[16:31]
    v_and_b32 v61, 0xffff0000, v78
    v_exp_f32 v54, v54
    v_lshlrev_b32 v62, 16, v79
    v_exp_f32 v55, v55
    v_and_b32 v63, 0xffff0000, v79
    v_add_f32 v48, 1.0, v48
    v_add_f32 v49, 1.0, v49
    ds_read_b128 a[16:19], v84 offset:384
    s_waitcnt lgkmcnt(4)
    v_mfma_f32_32x32x16_bf16 v[16:31], a[0:3], a[64:67], v[16:31]
    v_add_f32 v50, 1.0, v50
    v_add_f32 v51, 1.0, v51
    v_add_f32 v52, 1.0, v52
    v_add_f32 v53, 1.0, v53
    v_add_f32 v54, 1.0, v54
    v_add_f32 v55, 1.0, v55
    v_rcp_f32 v48, v48
    ds_read_b128 a[20:23], v85 offset:384
    s_waitcnt lgkmcnt(4)
    v_mfma_f32_32x32x16_bf16 v[16:31], a[4:7], a[68:71], v[16:31]
    v_rcp_f32 v49, v49
    v_rcp_f32 v50, v50
    v_rcp_f32 v51, v51
    v_rcp_f32 v52, v52
    v_rcp_f32 v53, v53
    v_rcp_f32 v54, v54
    v_rcp_f32 v55, v55
    ds_read_b128 a[24:27], v86 offset:384
    s_waitcnt lgkmcnt(4)
    v_mfma_f32_32x32x16_bf16 v[16:31], a[8:11], a[72:75], v[16:31]
    v_add_u32 v80, 2, v8
    v_lshrrev_b32 v81, 2, v80
    v_and_b32 v80, 3, v80
    v_lshl_add_u32 v81, v81, 12, v2
    v_lshl_add_u32 v83, v80, 8, v81
    v_cvt_pk_bf16_f32 v72, v48, v49
    v_cvt_pk_bf16_f32 v73, v50, v51
    ds_read_b128 a[28:31], v87 offset:384
    s_waitcnt lgkmcnt(4)
    v_mfma_f32_32x32x16_bf16 v[16:31], a[12:15], a[76:79], v[16:31]
    v_cvt_pk_bf16_f32 v74, v52, v53
    v_cvt_pk_bf16_f32 v75, v54, v55
    v_lshlrev_b32 v48, 16, v72
    v_and_b32 v49, 0xffff0000, v72
    v_lshlrev_b32 v50, 16, v73
    v_and_b32 v51, 0xffff0000, v73
    v_lshlrev_b32 v52, 16, v74
    ds_read_b128 a[0:3], v84 offset:512
    s_waitcnt lgkmcnt(4)
    v_mfma_f32_32x32x16_bf16 v[16:31], a[16:19], a[80:83], v[16:31]
    v_and_b32 v53, 0xffff0000, v74
    v_lshlrev_b32 v54, 16, v75
    v_and_b32 v55, 0xffff0000, v75
    v_mul_f32 v48, v48, v56
    v_mul_f32 v49, v49, v57
    v_mul_f32 v50, v50, v58
    v_mul_f32 v51, v51, v59
    ds_read_b128 a[4:7], v85 offset:512
    s_waitcnt lgkmcnt(4)
    v_mfma_f32_32x32x16_bf16 v[16:31], a[20:23], a[84:87], v[16:31]
    v_mul_f32 v52, v52, v60
    v_mul_f32 v53, v53, v61
    v_mul_f32 v54, v54, v62
    v_mul_f32 v55, v55, v63
    v_cvt_pk_bf16_f32 v68, v48, v49
    v_cvt_pk_bf16_f32 v69, v50, v51
    v_cvt_pk_bf16_f32 v70, v52, v53
    ds_read_b128 a[8:11], v86 offset:512
    s_waitcnt lgkmcnt(4)
    v_mfma_f32_32x32x16_bf16 v[16:31], a[24:27], a[88:91], v[16:31]
    v_cvt_pk_bf16_f32 v71, v54, v55
    buffer_store_dwordx4 v[68:71], v83, s[8:11], 0 offen sc1
    v_cvt_pk_bf16_f32 v72, v32, v33
    v_cvt_pk_bf16_f32 v76, v40, v41
    v_cvt_pk_bf16_f32 v73, v34, v35
    v_cvt_pk_bf16_f32 v77, v42, v43
    v_cvt_pk_bf16_f32 v74, v36, v37
    ds_read_b128 a[12:15], v87 offset:512
    s_waitcnt lgkmcnt(4)
    v_mfma_f32_32x32x16_bf16 v[16:31], a[28:31], a[92:95], v[16:31]
    v_cvt_pk_bf16_f32 v78, v44, v45
    v_cvt_pk_bf16_f32 v75, v38, v39
    v_cvt_pk_bf16_f32 v79, v46, v47
    v_lshlrev_b32 v32, 16, v72
    v_and_b32 v33, 0xffff0000, v72
    v_lshlrev_b32 v34, 16, v73
    v_and_b32 v35, 0xffff0000, v73
    ds_read_b128 a[16:19], v84 offset:640
    s_waitcnt lgkmcnt(4)
    v_mfma_f32_32x32x16_bf16 v[16:31], a[0:3], a[96:99], v[16:31]
    v_lshlrev_b32 v36, 16, v74
    v_and_b32 v37, 0xffff0000, v74
    v_lshlrev_b32 v38, 16, v75
    v_and_b32 v39, 0xffff0000, v75
    v_mul_f32 v32, 0xbfb8aa3b, v32
    v_mul_f32 v33, 0xbfb8aa3b, v33
    v_mul_f32 v34, 0xbfb8aa3b, v34
    ds_read_b128 a[20:23], v85 offset:640
    s_waitcnt lgkmcnt(4)
    v_mfma_f32_32x32x16_bf16 v[16:31], a[4:7], a[100:103], v[16:31]
    v_mul_f32 v35, 0xbfb8aa3b, v35
    v_mul_f32 v36, 0xbfb8aa3b, v36
    v_mul_f32 v37, 0xbfb8aa3b, v37
    v_mul_f32 v38, 0xbfb8aa3b, v38
    v_mul_f32 v39, 0xbfb8aa3b, v39
    v_exp_f32 v32, v32
    v_lshlrev_b32 v40, 16, v76
    ds_read_b128 a[24:27], v86 offset:640
    s_waitcnt lgkmcnt(4)
    v_mfma_f32_32x32x16_bf16 v[16:31], a[8:11], a[104:107], v[16:31]
    v_exp_f32 v33, v33
    v_and_b32 v41, 0xffff0000, v76
    v_exp_f32 v34, v34
    v_lshlrev_b32 v42, 16, v77
    v_exp_f32 v35, v35
    v_and_b32 v43, 0xffff0000, v77
    v_exp_f32 v36, v36
    ds_read_b128 a[28:31], v87 offset:640
    s_waitcnt lgkmcnt(4)
    v_mfma_f32_32x32x16_bf16 v[16:31], a[12:15], a[108:111], v[16:31]
    v_lshlrev_b32 v44, 16, v78
    v_exp_f32 v37, v37
    v_and_b32 v45, 0xffff0000, v78
    v_exp_f32 v38, v38
    v_lshlrev_b32 v46, 16, v79
    v_exp_f32 v39, v39
    v_and_b32 v47, 0xffff0000, v79
    ds_read_b128 a[0:3], v84 offset:768
    s_waitcnt lgkmcnt(4)
    v_mfma_f32_32x32x16_bf16 v[16:31], a[16:19], a[112:115], v[16:31]
    v_add_f32 v32, 1.0, v32
    v_add_f32 v33, 1.0, v33
    v_add_f32 v34, 1.0, v34
    v_add_f32 v35, 1.0, v35
    v_add_f32 v36, 1.0, v36
    v_add_f32 v37, 1.0, v37
    v_add_f32 v38, 1.0, v38
    ds_read_b128 a[4:7], v85 offset:768
    s_waitcnt lgkmcnt(4)
    v_mfma_f32_32x32x16_bf16 v[16:31], a[20:23], a[116:119], v[16:31]
    v_add_f32 v39, 1.0, v39
    v_rcp_f32 v32, v32
    v_rcp_f32 v33, v33
    v_rcp_f32 v34, v34
    v_rcp_f32 v35, v35
    v_rcp_f32 v36, v36
    v_rcp_f32 v37, v37
    ds_read_b128 a[8:11], v86 offset:768
    s_waitcnt lgkmcnt(4)
    v_mfma_f32_32x32x16_bf16 v[16:31], a[24:27], a[120:123], v[16:31]
    v_rcp_f32 v38, v38
    v_rcp_f32 v39, v39
    v_add_u32 v80, 0, v8
    v_lshrrev_b32 v81, 2, v80
    v_and_b32 v80, 3, v80
    v_lshl_add_u32 v81, v81, 12, v2
    v_lshl_add_u32 v82, v80, 8, v81
    ds_read_b128 a[12:15], v87 offset:768
    s_waitcnt lgkmcnt(4)
    v_mfma_f32_32x32x16_bf16 v[16:31], a[28:31], a[124:127], v[16:31]
    v_cvt_pk_bf16_f32 v72, v32, v33
    v_cvt_pk_bf16_f32 v73, v34, v35
    v_cvt_pk_bf16_f32 v74, v36, v37
    v_cvt_pk_bf16_f32 v75, v38, v39
    v_lshlrev_b32 v32, 16, v72
    v_and_b32 v33, 0xffff0000, v72
    v_lshlrev_b32 v34, 16, v73
    ds_read_b128 a[16:19], v84 offset:896
    s_waitcnt lgkmcnt(4)
    v_mfma_f32_32x32x16_bf16 v[16:31], a[0:3], a[128:131], v[16:31]
    v_and_b32 v35, 0xffff0000, v73
    v_lshlrev_b32 v36, 16, v74
    v_and_b32 v37, 0xffff0000, v74
    v_lshlrev_b32 v38, 16, v75
    v_and_b32 v39, 0xffff0000, v75
    v_mul_f32 v32, v32, v40
    ds_read_b128 a[20:23], v85 offset:896
    s_waitcnt lgkmcnt(4)
    v_mfma_f32_32x32x16_bf16 v[16:31], a[4:7], a[132:135], v[16:31]
    v_mul_f32 v33, v33, v41
    v_mul_f32 v34, v34, v42
    v_mul_f32 v35, v35, v43
    v_mul_f32 v36, v36, v44
    v_mul_f32 v37, v37, v45
    v_mul_f32 v38, v38, v46
    ds_read_b128 a[24:27], v86 offset:896
    s_waitcnt lgkmcnt(4)
    v_mfma_f32_32x32x16_bf16 v[16:31], a[8:11], a[136:139], v[16:31]
    v_mul_f32 v39, v39, v47
    v_cvt_pk_bf16_f32 v64, v32, v33
    v_cvt_pk_bf16_f32 v65, v34, v35
    v_cvt_pk_bf16_f32 v66, v36, v37
    v_cvt_pk_bf16_f32 v67, v38, v39
    buffer_store_dwordx4 v[64:67], v82, s[8:11], 0 offen sc1
    ds_read_b128 a[28:31], v87 offset:896
    s_waitcnt lgkmcnt(4)
    v_mfma_f32_32x32x16_bf16 v[16:31], a[12:15], a[140:143], v[16:31]
    s_barrier
    ds_read_b128 a[0:3], v88 offset:0
    s_waitcnt lgkmcnt(4)
    v_mfma_f32_32x32x16_bf16 v[16:31], a[16:19], a[144:147], v[16:31]
    ds_read_b128 a[4:7], v89 offset:0
    s_waitcnt lgkmcnt(4)
    v_mfma_f32_32x32x16_bf16 v[16:31], a[20:23], a[148:151], v[16:31]
    ds_read_b128 a[8:11], v90 offset:0
    s_waitcnt lgkmcnt(4)
    v_mfma_f32_32x32x16_bf16 v[16:31], a[24:27], a[152:155], v[16:31]
    ds_read_b128 a[12:15], v91 offset:0
    s_waitcnt lgkmcnt(4)
    v_mfma_f32_32x32x16_bf16 v[16:31], a[28:31], a[156:159], v[16:31]
    ds_read_b128 a[16:19], v88 offset:128
    s_waitcnt lgkmcnt(4)
    v_mfma_f32_32x32x16_bf16 v[32:47], a[0:3], a[32:35], 0
    ds_read_b128 a[20:23], v89 offset:128
    s_waitcnt lgkmcnt(4)
    v_mfma_f32_32x32x16_bf16 v[32:47], a[4:7], a[36:39], v[32:47]
    ds_read_b128 a[24:27], v90 offset:128
    s_waitcnt lgkmcnt(4)
    v_mfma_f32_32x32x16_bf16 v[32:47], a[8:11], a[40:43], v[32:47]
    s_nop 2
    ds_write_b128 v7, v[16:19] offset:0
    ds_read_b128 a[28:31], v91 offset:128
    s_waitcnt lgkmcnt(5)
    v_mfma_f32_32x32x16_bf16 v[32:47], a[12:15], a[44:47], v[32:47]
    ds_write_b128 v7, v[20:23] offset:32
    ds_read_b128 a[0:3], v88 offset:256
    s_waitcnt lgkmcnt(6)
    v_mfma_f32_32x32x16_bf16 v[32:47], a[16:19], a[48:51], v[32:47]
    ds_write_b128 v7, v[24:27] offset:64
    ds_read_b128 a[4:7], v89 offset:256
    s_waitcnt lgkmcnt(7)
    v_mfma_f32_32x32x16_bf16 v[32:47], a[20:23], a[52:55], v[32:47]
    ds_write_b128 v7, v[28:31] offset:96
    ds_read_b128 a[8:11], v90 offset:256
    s_waitcnt lgkmcnt(8)
    v_mfma_f32_32x32x16_bf16 v[32:47], a[24:27], a[56:59], v[32:47]
    ds_read_b128 a[12:15], v91 offset:256
    s_waitcnt lgkmcnt(7)
    v_mfma_f32_32x32x16_bf16 v[32:47], a[28:31], a[60:63], v[32:47]
    ds_read_b128 a[16:19], v88 offset:384
    s_waitcnt lgkmcnt(6)
    v_mfma_f32_32x32x16_bf16 v[32:47], a[0:3], a[64:67], v[32:47]
    ds_read_b128 a[20:23], v89 offset:384
    s_waitcnt lgkmcnt(5)
    v_mfma_f32_32x32x16_bf16 v[32:47], a[4:7], a[68:71], v[32:47]
    ds_read_b128 a[24:27], v90 offset:384
    s_waitcnt lgkmcnt(4)
    v_mfma_f32_32x32x16_bf16 v[32:47], a[8:11], a[72:75], v[32:47]
    ds_read_b128 a[28:31], v91 offset:384
    s_waitcnt lgkmcnt(4)
    v_mfma_f32_32x32x16_bf16 v[32:47], a[12:15], a[76:79], v[32:47]
    ds_read_b128 a[0:3], v88 offset:512
    s_waitcnt lgkmcnt(4)
    v_mfma_f32_32x32x16_bf16 v[32:47], a[16:19], a[80:83], v[32:47]
    ds_read_b128 a[4:7], v89 offset:512
    s_waitcnt lgkmcnt(4)
    v_mfma_f32_32x32x16_bf16 v[32:47], a[20:23], a[84:87], v[32:47]
    ds_read_b128 a[8:11], v90 offset:512
    s_waitcnt lgkmcnt(4)
    v_mfma_f32_32x32x16_bf16 v[32:47], a[24:27], a[88:91], v[32:47]
    ds_read_b128 a[12:15], v91 offset:512
    s_waitcnt lgkmcnt(4)
    v_mfma_f32_32x32x16_bf16 v[32:47], a[28:31], a[92:95], v[32:47]
    ds_read_b128 a[16:19], v88 offset:640
    s_waitcnt lgkmcnt(4)
    v_mfma_f32_32x32x16_bf16 v[32:47], a[0:3], a[96:99], v[32:47]
    ds_read_b128 a[20:23], v89 offset:640
    s_waitcnt lgkmcnt(4)
    v_mfma_f32_32x32x16_bf16 v[32:47], a[4:7], a[100:103], v[32:47]
    ds_read_b128 a[24:27], v90 offset:640
    s_waitcnt lgkmcnt(4)
    v_mfma_f32_32x32x16_bf16 v[32:47], a[8:11], a[104:107], v[32:47]
    ds_read_b128 a[28:31], v91 offset:640
    s_waitcnt lgkmcnt(4)
    v_mfma_f32_32x32x16_bf16 v[32:47], a[12:15], a[108:111], v[32:47]
    ds_read_b128 a[0:3], v88 offset:768
    s_waitcnt lgkmcnt(4)
    v_mfma_f32_32x32x16_bf16 v[32:47], a[16:19], a[112:115], v[32:47]
    ds_read_b128 a[4:7], v89 offset:768
    s_waitcnt lgkmcnt(4)
    v_mfma_f32_32x32x16_bf16 v[32:47], a[20:23], a[116:119], v[32:47]
    ds_read_b128 a[8:11], v90 offset:768
    s_waitcnt lgkmcnt(4)
    v_mfma_f32_32x32x16_bf16 v[32:47], a[24:27], a[120:123], v[32:47]
    ds_read_b128 a[12:15], v91 offset:768
    s_waitcnt lgkmcnt(4)
    v_mfma_f32_32x32x16_bf16 v[32:47], a[28:31], a[124:127], v[32:47]
    ds_read_b128 a[16:19], v88 offset:896
    s_waitcnt lgkmcnt(4)
    v_mfma_f32_32x32x16_bf16 v[32:47], a[0:3], a[128:131], v[32:47]
    ds_read_b128 a[20:23], v89 offset:896
    s_waitcnt lgkmcnt(4)
    v_mfma_f32_32x32x16_bf16 v[32:47], a[4:7], a[132:135], v[32:47]
    ds_read_b128 a[24:27], v90 offset:896
    s_waitcnt lgkmcnt(4)
    v_mfma_f32_32x32x16_bf16 v[32:47], a[8:11], a[136:139], v[32:47]
    ds_read_b128 a[28:31], v91 offset:896
    s_waitcnt lgkmcnt(4)
    v_mfma_f32_32x32x16_bf16 v[32:47], a[12:15], a[140:143], v[32:47]
    s_barrier
    ds_read_b128 a[0:3], v6 offset:32768
    s_waitcnt lgkmcnt(4)
    v_mfma_f32_32x32x16_bf16 v[32:47], a[16:19], a[144:147], v[32:47]
    ds_read_b128 a[4:7], v6 offset:33792
    s_waitcnt lgkmcnt(4)
    v_mfma_f32_32x32x16_bf16 v[32:47], a[20:23], a[148:151], v[32:47]
    ds_read_b128 a[8:11], v6 offset:34816
    s_waitcnt lgkmcnt(4)
    v_mfma_f32_32x32x16_bf16 v[32:47], a[24:27], a[152:155], v[32:47]
    ds_read_b128 a[12:15], v6 offset:35840
    s_waitcnt lgkmcnt(4)
    v_mfma_f32_32x32x16_bf16 v[32:47], a[28:31], a[156:159], v[32:47]
    ds_read_b128 a[16:19], v6 offset:36864
    s_waitcnt lgkmcnt(4)
    v_mfma_f32_32x32x16_bf16 v[48:63], a[0:3], a[32:35], 0
    ds_read_b128 a[20:23], v6 offset:37888
    s_waitcnt lgkmcnt(4)
    v_mfma_f32_32x32x16_bf16 v[48:63], a[4:7], a[36:39], v[48:63]
    ds_read_b128 a[24:27], v6 offset:38912
    s_waitcnt lgkmcnt(4)
    v_mfma_f32_32x32x16_bf16 v[48:63], a[8:11], a[40:43], v[48:63]
    s_nop 2
    ds_write_b128 v7, v[32:35] offset:128
    ds_read_b128 a[28:31], v6 offset:39936
    s_waitcnt lgkmcnt(5)
    v_mfma_f32_32x32x16_bf16 v[48:63], a[12:15], a[44:47], v[48:63]
    ds_write_b128 v7, v[36:39] offset:160
    ds_read_b128 a[0:3], v6 offset:40960
    s_waitcnt lgkmcnt(6)
    v_mfma_f32_32x32x16_bf16 v[48:63], a[16:19], a[48:51], v[48:63]
    ds_write_b128 v7, v[40:43] offset:192
    ds_read_b128 a[4:7], v6 offset:41984
    s_waitcnt lgkmcnt(7)
    v_mfma_f32_32x32x16_bf16 v[48:63], a[20:23], a[52:55], v[48:63]
    ds_write_b128 v7, v[44:47] offset:224
    ds_read_b128 a[8:11], v6 offset:43008
    s_waitcnt lgkmcnt(8)
    v_mfma_f32_32x32x16_bf16 v[48:63], a[24:27], a[56:59], v[48:63]
    ds_read_b128 a[12:15], v6 offset:44032
    s_waitcnt lgkmcnt(7)
    v_mfma_f32_32x32x16_bf16 v[48:63], a[28:31], a[60:63], v[48:63]
    ds_read_b128 a[16:19], v6 offset:45056
    s_waitcnt lgkmcnt(6)
    v_mfma_f32_32x32x16_bf16 v[48:63], a[0:3], a[64:67], v[48:63]
    ds_read_b128 a[20:23], v6 offset:46080
    s_waitcnt lgkmcnt(5)
    v_mfma_f32_32x32x16_bf16 v[48:63], a[4:7], a[68:71], v[48:63]
    ds_read_b128 a[24:27], v6 offset:47104
    s_waitcnt lgkmcnt(4)
    v_mfma_f32_32x32x16_bf16 v[48:63], a[8:11], a[72:75], v[48:63]
    ds_read_b128 a[28:31], v6 offset:48128
    s_waitcnt lgkmcnt(4)
    v_mfma_f32_32x32x16_bf16 v[48:63], a[12:15], a[76:79], v[48:63]
    ds_read_b128 a[0:3], v6 offset:49152
    s_waitcnt lgkmcnt(4)
    v_mfma_f32_32x32x16_bf16 v[48:63], a[16:19], a[80:83], v[48:63]
    ds_read_b128 a[4:7], v6 offset:50176
    s_waitcnt lgkmcnt(4)
    v_mfma_f32_32x32x16_bf16 v[48:63], a[20:23], a[84:87], v[48:63]
    ds_read_b128 a[8:11], v6 offset:51200
    s_waitcnt lgkmcnt(4)
    v_mfma_f32_32x32x16_bf16 v[48:63], a[24:27], a[88:91], v[48:63]
    ds_read_b128 a[12:15], v6 offset:52224
    s_waitcnt lgkmcnt(4)
    v_mfma_f32_32x32x16_bf16 v[48:63], a[28:31], a[92:95], v[48:63]
    ds_read_b128 a[16:19], v6 offset:53248
    s_waitcnt lgkmcnt(4)
    v_mfma_f32_32x32x16_bf16 v[48:63], a[0:3], a[96:99], v[48:63]
    ds_read_b128 a[20:23], v6 offset:54272
    s_waitcnt lgkmcnt(4)
    v_mfma_f32_32x32x16_bf16 v[48:63], a[4:7], a[100:103], v[48:63]
    ds_read_b128 a[24:27], v6 offset:55296
    s_waitcnt lgkmcnt(4)
    v_mfma_f32_32x32x16_bf16 v[48:63], a[8:11], a[104:107], v[48:63]
    ds_read_b128 a[28:31], v6 offset:56320
    s_waitcnt lgkmcnt(4)
    v_mfma_f32_32x32x16_bf16 v[48:63], a[12:15], a[108:111], v[48:63]
    ds_read_b128 a[0:3], v6 offset:57344
    s_waitcnt lgkmcnt(4)
    v_mfma_f32_32x32x16_bf16 v[48:63], a[16:19], a[112:115], v[48:63]
    ds_read_b128 a[4:7], v6 offset:58368
    s_waitcnt lgkmcnt(4)
    v_mfma_f32_32x32x16_bf16 v[48:63], a[20:23], a[116:119], v[48:63]
    ds_read_b128 a[8:11], v6 offset:59392
    s_waitcnt lgkmcnt(4)
    v_mfma_f32_32x32x16_bf16 v[48:63], a[24:27], a[120:123], v[48:63]
    ds_read_b128 a[12:15], v6 offset:60416
    s_waitcnt lgkmcnt(4)
    v_mfma_f32_32x32x16_bf16 v[48:63], a[28:31], a[124:127], v[48:63]
    ds_read_b128 a[16:19], v6 offset:61440
    s_waitcnt lgkmcnt(4)
    v_mfma_f32_32x32x16_bf16 v[48:63], a[0:3], a[128:131], v[48:63]
    ds_read_b128 a[20:23], v6 offset:62464
    s_waitcnt lgkmcnt(4)
    v_mfma_f32_32x32x16_bf16 v[48:63], a[4:7], a[132:135], v[48:63]
    ds_read_b128 a[24:27], v6 offset:63488
    s_waitcnt lgkmcnt(4)
    v_mfma_f32_32x32x16_bf16 v[48:63], a[8:11], a[136:139], v[48:63]
    ds_read_b128 a[28:31], v6 offset:64512
    s_waitcnt lgkmcnt(4)
    v_mfma_f32_32x32x16_bf16 v[48:63], a[12:15], a[140:143], v[48:63]
    s_barrier
    ds_read_b128 a[0:3], v5 offset:0
    s_waitcnt lgkmcnt(4)
    v_mfma_f32_32x32x16_bf16 v[48:63], a[16:19], a[144:147], v[48:63]
    ds_read_b128 a[4:7], v5 offset:1024
    s_waitcnt lgkmcnt(4)
    v_mfma_f32_32x32x16_bf16 v[48:63], a[20:23], a[148:151], v[48:63]
    ds_read_b128 a[8:11], v5 offset:2048
    s_waitcnt lgkmcnt(4)
    v_mfma_f32_32x32x16_bf16 v[48:63], a[24:27], a[152:155], v[48:63]
    ds_read_b128 a[12:15], v5 offset:3072
    s_waitcnt lgkmcnt(4)
    v_mfma_f32_32x32x16_bf16 v[48:63], a[28:31], a[156:159], v[48:63]
    ds_read_b128 a[16:19], v5 offset:4096
    s_waitcnt lgkmcnt(4)
    v_mfma_f32_32x32x16_bf16 v[32:47], a[0:3], a[32:35], 0
    ds_read_b128 a[20:23], v5 offset:5120
    s_waitcnt lgkmcnt(4)
    v_mfma_f32_32x32x16_bf16 v[32:47], a[4:7], a[36:39], v[32:47]
    ds_read_b128 a[24:27], v5 offset:6144
    s_waitcnt lgkmcnt(4)
    v_mfma_f32_32x32x16_bf16 v[32:47], a[8:11], a[40:43], v[32:47]
    s_nop 2
    v_cvt_pk_bf16_f32 v72, v48, v49
    v_cvt_pk_bf16_f32 v76, v56, v57
    v_cvt_pk_bf16_f32 v73, v50, v51
    v_cvt_pk_bf16_f32 v77, v58, v59
    ds_read_b128 a[28:31], v5 offset:7168
    s_waitcnt lgkmcnt(4)
    v_mfma_f32_32x32x16_bf16 v[32:47], a[12:15], a[44:47], v[32:47]
    v_cvt_pk_bf16_f32 v74, v52, v53
    v_cvt_pk_bf16_f32 v78, v60, v61
    v_cvt_pk_bf16_f32 v75, v54, v55
    v_cvt_pk_bf16_f32 v79, v62, v63
    ds_read_b128 a[0:3], v5 offset:8192
    s_waitcnt lgkmcnt(4)
    v_mfma_f32_32x32x16_bf16 v[32:47], a[16:19], a[48:51], v[32:47]
    v_lshlrev_b32 v48, 16, v72
    v_and_b32 v49, 0xffff0000, v72
    v_lshlrev_b32 v50, 16, v73
    v_and_b32 v51, 0xffff0000, v73
    ds_read_b128 a[4:7], v5 offset:9216
    s_waitcnt lgkmcnt(4)
    v_mfma_f32_32x32x16_bf16 v[32:47], a[20:23], a[52:55], v[32:47]
    v_lshlrev_b32 v52, 16, v74
    v_and_b32 v53, 0xffff0000, v74
    v_lshlrev_b32 v54, 16, v75
    v_and_b32 v55, 0xffff0000, v75
    ds_read_b128 a[8:11], v5 offset:10240
    s_waitcnt lgkmcnt(4)
    v_mfma_f32_32x32x16_bf16 v[32:47], a[24:27], a[56:59], v[32:47]
    v_mul_f32 v48, 0xbfb8aa3b, v48
    v_mul_f32 v49, 0xbfb8aa3b, v49
    v_mul_f32 v50, 0xbfb8aa3b, v50
    v_mul_f32 v51, 0xbfb8aa3b, v51
    ds_read_b128 a[12:15], v5 offset:11264
    s_waitcnt lgkmcnt(4)
    v_mfma_f32_32x32x16_bf16 v[32:47], a[28:31], a[60:63], v[32:47]
    v_mul_f32 v52, 0xbfb8aa3b, v52
    v_mul_f32 v53, 0xbfb8aa3b, v53
    v_mul_f32 v54, 0xbfb8aa3b, v54
    v_mul_f32 v55, 0xbfb8aa3b, v55
    ds_read_b128 a[16:19], v5 offset:12288
    s_waitcnt lgkmcnt(4)
    v_mfma_f32_32x32x16_bf16 v[32:47], a[0:3], a[64:67], v[32:47]
    v_exp_f32 v48, v48
    v_lshlrev_b32 v56, 16, v76
    v_exp_f32 v49, v49
    v_and_b32 v57, 0xffff0000, v76
    ds_read_b128 a[20:23], v5 offset:13312
    s_waitcnt lgkmcnt(4)
    v_mfma_f32_32x32x16_bf16 v[32:47], a[4:7], a[68:71], v[32:47]
    v_exp_f32 v50, v50
    v_lshlrev_b32 v58, 16, v77
    v_exp_f32 v51, v51
    v_and_b32 v59, 0xffff0000, v77
    ds_read_b128 a[24:27], v5 offset:14336
    s_waitcnt lgkmcnt(4)
    v_mfma_f32_32x32x16_bf16 v[32:47], a[8:11], a[72:75], v[32:47]
    v_exp_f32 v52, v52
    v_lshlrev_b32 v60, 16, v78
    v_exp_f32 v53, v53
    v_and_b32 v61, 0xffff0000, v78
    ds_read_b128 a[28:31], v5 offset:15360
    s_waitcnt lgkmcnt(4)
    v_mfma_f32_32x32x16_bf16 v[32:47], a[12:15], a[76:79], v[32:47]
    v_exp_f32 v54, v54
    v_lshlrev_b32 v62, 16, v79
    v_exp_f32 v55, v55
    v_and_b32 v63, 0xffff0000, v79
    ds_read_b128 a[0:3], v5 offset:16384
    s_waitcnt lgkmcnt(4)
    v_mfma_f32_32x32x16_bf16 v[32:47], a[16:19], a[80:83], v[32:47]
    v_add_f32 v48, 1.0, v48
    v_add_f32 v49, 1.0, v49
    v_add_f32 v50, 1.0, v50
    v_add_f32 v51, 1.0, v51
    ds_read_b128 a[4:7], v5 offset:17408
    s_waitcnt lgkmcnt(4)
    v_mfma_f32_32x32x16_bf16 v[32:47], a[20:23], a[84:87], v[32:47]
    v_add_f32 v52, 1.0, v52
    v_add_f32 v53, 1.0, v53
    v_add_f32 v54, 1.0, v54
    ds_read_b128 a[8:11], v5 offset:18432
    s_waitcnt lgkmcnt(4)
    v_mfma_f32_32x32x16_bf16 v[32:47], a[24:27], a[88:91], v[32:47]
    v_add_f32 v55, 1.0, v55
    v_rcp_f32 v48, v48
    v_rcp_f32 v49, v49
    ds_read_b128 a[12:15], v5 offset:19456
    s_waitcnt lgkmcnt(4)
    v_mfma_f32_32x32x16_bf16 v[32:47], a[28:31], a[92:95], v[32:47]
    v_rcp_f32 v50, v50
    v_rcp_f32 v51, v51
    v_rcp_f32 v52, v52
    ds_read_b128 a[16:19], v5 offset:20480
    s_waitcnt lgkmcnt(4)
    v_mfma_f32_32x32x16_bf16 v[32:47], a[0:3], a[96:99], v[32:47]
    v_rcp_f32 v53, v53
    v_rcp_f32 v54, v54
    v_rcp_f32 v55, v55
    ds_read_b128 a[20:23], v5 offset:21504
    s_waitcnt lgkmcnt(4)
    v_mfma_f32_32x32x16_bf16 v[32:47], a[4:7], a[100:103], v[32:47]
    v_add_u32 v80, 4, v8
    v_lshrrev_b32 v81, 2, v80
    v_and_b32 v80, 3, v80
    ds_read_b128 a[24:27], v5 offset:22528
    s_waitcnt lgkmcnt(4)
    v_mfma_f32_32x32x16_bf16 v[32:47], a[8:11], a[104:107], v[32:47]
    v_lshl_add_u32 v81, v81, 12, v2
    v_lshl_add_u32 v82, v80, 8, v81
    v_cvt_pk_bf16_f32 v72, v48, v49
    ds_read_b128 a[28:31], v5 offset:23552
    s_waitcnt lgkmcnt(4)
    v_mfma_f32_32x32x16_bf16 v[32:47], a[12:15], a[108:111], v[32:47]
    v_cvt_pk_bf16_f32 v73, v50, v51
    v_cvt_pk_bf16_f32 v74, v52, v53
    v_cvt_pk_bf16_f32 v75, v54, v55
    ds_read_b128 a[0:3], v5 offset:24576
    s_waitcnt lgkmcnt(4)
    v_mfma_f32_32x32x16_bf16 v[32:47], a[16:19], a[112:115], v[32:47]
    v_lshlrev_b32 v48, 16, v72
    v_and_b32 v49, 0xffff0000, v72
    v_lshlrev_b32 v50, 16, v73
    ds_read_b128 a[4:7], v5 offset:25600
    s_waitcnt lgkmcnt(4)
    v_mfma_f32_32x32x16_bf16 v[32:47], a[20:23], a[116:119], v[32:47]
    v_and_b32 v51, 0xffff0000, v73
    v_lshlrev_b32 v52, 16, v74
    v_and_b32 v53, 0xffff0000, v74
    ds_read_b128 a[8:11], v5 offset:26624
    s_waitcnt lgkmcnt(4)
    v_mfma_f32_32x32x16_bf16 v[32:47], a[24:27], a[120:123], v[32:47]
    v_lshlrev_b32 v54, 16, v75
    v_and_b32 v55, 0xffff0000, v75
    v_mul_f32 v48, v48, v56
    ds_read_b128 a[12:15], v5 offset:27648
    s_waitcnt lgkmcnt(4)
    v_mfma_f32_32x32x16_bf16 v[32:47], a[28:31], a[124:127], v[32:47]
    v_mul_f32 v49, v49, v57
    v_mul_f32 v50, v50, v58
    v_mul_f32 v51, v51, v59
    ds_read_b128 a[16:19], v5 offset:28672
    s_waitcnt lgkmcnt(4)
    v_mfma_f32_32x32x16_bf16 v[32:47], a[0:3], a[128:131], v[32:47]
    v_mul_f32 v52, v52, v60
    v_mul_f32 v53, v53, v61
    v_mul_f32 v54, v54, v62
    ds_read_b128 a[20:23], v5 offset:29696
    s_waitcnt lgkmcnt(4)
    v_mfma_f32_32x32x16_bf16 v[32:47], a[4:7], a[132:135], v[32:47]
    v_mul_f32 v55, v55, v63
    v_cvt_pk_bf16_f32 v64, v48, v49
    v_cvt_pk_bf16_f32 v65, v50, v51
    ds_read_b128 a[24:27], v5 offset:30720
    s_waitcnt lgkmcnt(4)
    v_mfma_f32_32x32x16_bf16 v[32:47], a[8:11], a[136:139], v[32:47]
    v_cvt_pk_bf16_f32 v66, v52, v53
    v_cvt_pk_bf16_f32 v67, v54, v55
    buffer_store_dwordx4 v[64:67], v82, s[8:11], 0 offen sc1
    ds_read_b128 a[28:31], v5 offset:31744
    s_waitcnt lgkmcnt(4)
    v_mfma_f32_32x32x16_bf16 v[32:47], a[12:15], a[140:143], v[32:47]
    s_barrier
    ds_read_b128 a[0:3], v6 offset:0
    s_waitcnt lgkmcnt(4)
    v_mfma_f32_32x32x16_bf16 v[32:47], a[16:19], a[144:147], v[32:47]
    ds_read_b128 a[4:7], v6 offset:1024
    s_waitcnt lgkmcnt(4)
    v_mfma_f32_32x32x16_bf16 v[32:47], a[20:23], a[148:151], v[32:47]
    ds_read_b128 a[8:11], v6 offset:2048
    s_waitcnt lgkmcnt(4)
    v_mfma_f32_32x32x16_bf16 v[32:47], a[24:27], a[152:155], v[32:47]
    ds_read_b128 a[12:15], v6 offset:3072
    s_waitcnt lgkmcnt(4)
    v_mfma_f32_32x32x16_bf16 v[32:47], a[28:31], a[156:159], v[32:47]
    ds_read_b128 a[16:19], v6 offset:4096
    s_waitcnt lgkmcnt(4)
    v_mfma_f32_32x32x16_bf16 v[48:63], a[0:3], a[32:35], 0
    ds_read_b128 a[20:23], v6 offset:5120
    s_waitcnt lgkmcnt(4)
    v_mfma_f32_32x32x16_bf16 v[48:63], a[4:7], a[36:39], v[48:63]
    ds_read_b128 a[24:27], v6 offset:6144
    s_waitcnt lgkmcnt(4)
    v_mfma_f32_32x32x16_bf16 v[48:63], a[8:11], a[40:43], v[48:63]
    s_nop 2
    v_cvt_pk_bf16_f32 v72, v32, v33
    v_cvt_pk_bf16_f32 v76, v40, v41
    v_cvt_pk_bf16_f32 v73, v34, v35
    v_cvt_pk_bf16_f32 v77, v42, v43
    ds_read_b128 a[28:31], v6 offset:7168
    s_waitcnt lgkmcnt(4)
    v_mfma_f32_32x32x16_bf16 v[48:63], a[12:15], a[44:47], v[48:63]
    v_cvt_pk_bf16_f32 v74, v36, v37
    v_cvt_pk_bf16_f32 v78, v44, v45
    v_cvt_pk_bf16_f32 v75, v38, v39
    v_cvt_pk_bf16_f32 v79, v46, v47
    ds_read_b128 a[0:3], v6 offset:8192
    s_waitcnt lgkmcnt(4)
    v_mfma_f32_32x32x16_bf16 v[48:63], a[16:19], a[48:51], v[48:63]
    v_lshlrev_b32 v32, 16, v72
    v_and_b32 v33, 0xffff0000, v72
    v_lshlrev_b32 v34, 16, v73
    v_and_b32 v35, 0xffff0000, v73
    ds_read_b128 a[4:7], v6 offset:9216
    s_waitcnt lgkmcnt(4)
    v_mfma_f32_32x32x16_bf16 v[48:63], a[20:23], a[52:55], v[48:63]
    v_lshlrev_b32 v36, 16, v74
    v_and_b32 v37, 0xffff0000, v74
    v_lshlrev_b32 v38, 16, v75
    v_and_b32 v39, 0xffff0000, v75
    ds_read_b128 a[8:11], v6 offset:10240
    s_waitcnt lgkmcnt(4)
    v_mfma_f32_32x32x16_bf16 v[48:63], a[24:27], a[56:59], v[48:63]
    v_mul_f32 v32, 0xbfb8aa3b, v32
    v_mul_f32 v33, 0xbfb8aa3b, v33
    v_mul_f32 v34, 0xbfb8aa3b, v34
    v_mul_f32 v35, 0xbfb8aa3b, v35
    ds_read_b128 a[12:15], v6 offset:11264
    s_waitcnt lgkmcnt(4)
    v_mfma_f32_32x32x16_bf16 v[48:63], a[28:31], a[60:63], v[48:63]
    v_mul_f32 v36, 0xbfb8aa3b, v36
    v_mul_f32 v37, 0xbfb8aa3b, v37
    v_mul_f32 v38, 0xbfb8aa3b, v38
    v_mul_f32 v39, 0xbfb8aa3b, v39
    ds_read_b128 a[16:19], v6 offset:12288
    s_waitcnt lgkmcnt(4)
    v_mfma_f32_32x32x16_bf16 v[48:63], a[0:3], a[64:67], v[48:63]
    v_exp_f32 v32, v32
    v_lshlrev_b32 v40, 16, v76
    v_exp_f32 v33, v33
    v_and_b32 v41, 0xffff0000, v76
    ds_read_b128 a[20:23], v6 offset:13312
    s_waitcnt lgkmcnt(4)
    v_mfma_f32_32x32x16_bf16 v[48:63], a[4:7], a[68:71], v[48:63]
    v_exp_f32 v34, v34
    v_lshlrev_b32 v42, 16, v77
    v_exp_f32 v35, v35
    v_and_b32 v43, 0xffff0000, v77
    ds_read_b128 a[24:27], v6 offset:14336
    s_waitcnt lgkmcnt(4)
    v_mfma_f32_32x32x16_bf16 v[48:63], a[8:11], a[72:75], v[48:63]
    v_exp_f32 v36, v36
    v_lshlrev_b32 v44, 16, v78
    v_exp_f32 v37, v37
    v_and_b32 v45, 0xffff0000, v78
    ds_read_b128 a[28:31], v6 offset:15360
    s_waitcnt lgkmcnt(4)
    v_mfma_f32_32x32x16_bf16 v[48:63], a[12:15], a[76:79], v[48:63]
    v_exp_f32 v38, v38
    v_lshlrev_b32 v46, 16, v79
    v_exp_f32 v39, v39
    v_and_b32 v47, 0xffff0000, v79
    ds_read_b128 a[0:3], v6 offset:16384
    s_waitcnt lgkmcnt(4)
    v_mfma_f32_32x32x16_bf16 v[48:63], a[16:19], a[80:83], v[48:63]
    v_add_f32 v32, 1.0, v32
    v_add_f32 v33, 1.0, v33
    v_add_f32 v34, 1.0, v34
    v_add_f32 v35, 1.0, v35
    ds_read_b128 a[4:7], v6 offset:17408
    s_waitcnt lgkmcnt(4)
    v_mfma_f32_32x32x16_bf16 v[48:63], a[20:23], a[84:87], v[48:63]
    v_add_f32 v36, 1.0, v36
    v_add_f32 v37, 1.0, v37
    v_add_f32 v38, 1.0, v38
    ds_read_b128 a[8:11], v6 offset:18432
    s_waitcnt lgkmcnt(4)
    v_mfma_f32_32x32x16_bf16 v[48:63], a[24:27], a[88:91], v[48:63]
    v_add_f32 v39, 1.0, v39
    v_rcp_f32 v32, v32
    v_rcp_f32 v33, v33
    ds_read_b128 a[12:15], v6 offset:19456
    s_waitcnt lgkmcnt(4)
    v_mfma_f32_32x32x16_bf16 v[48:63], a[28:31], a[92:95], v[48:63]
    v_rcp_f32 v34, v34
    v_rcp_f32 v35, v35
    v_rcp_f32 v36, v36
    ds_read_b128 a[16:19], v6 offset:20480
    s_waitcnt lgkmcnt(4)
    v_mfma_f32_32x32x16_bf16 v[48:63], a[0:3], a[96:99], v[48:63]
    v_rcp_f32 v37, v37
    v_rcp_f32 v38, v38
    v_rcp_f32 v39, v39
    ds_read_b128 a[20:23], v6 offset:21504
    s_waitcnt lgkmcnt(4)
    v_mfma_f32_32x32x16_bf16 v[48:63], a[4:7], a[100:103], v[48:63]
    v_add_u32 v80, 6, v8
    v_lshrrev_b32 v81, 2, v80
    v_and_b32 v80, 3, v80
    ds_read_b128 a[24:27], v6 offset:22528
    s_waitcnt lgkmcnt(4)
    v_mfma_f32_32x32x16_bf16 v[48:63], a[8:11], a[104:107], v[48:63]
    v_lshl_add_u32 v81, v81, 12, v2
    v_lshl_add_u32 v83, v80, 8, v81
    v_cvt_pk_bf16_f32 v72, v32, v33
    ds_read_b128 a[28:31], v6 offset:23552
    s_waitcnt lgkmcnt(4)
    v_mfma_f32_32x32x16_bf16 v[48:63], a[12:15], a[108:111], v[48:63]
    v_cvt_pk_bf16_f32 v73, v34, v35
    v_cvt_pk_bf16_f32 v74, v36, v37
    v_cvt_pk_bf16_f32 v75, v38, v39
    ds_read_b128 a[0:3], v6 offset:24576
    s_waitcnt lgkmcnt(4)
    v_mfma_f32_32x32x16_bf16 v[48:63], a[16:19], a[112:115], v[48:63]
    v_lshlrev_b32 v32, 16, v72
    v_and_b32 v33, 0xffff0000, v72
    v_lshlrev_b32 v34, 16, v73
    ds_read_b128 a[4:7], v6 offset:25600
    s_waitcnt lgkmcnt(4)
    v_mfma_f32_32x32x16_bf16 v[48:63], a[20:23], a[116:119], v[48:63]
    v_and_b32 v35, 0xffff0000, v73
    v_lshlrev_b32 v36, 16, v74
    v_and_b32 v37, 0xffff0000, v74
    ds_read_b128 a[8:11], v6 offset:26624
    s_waitcnt lgkmcnt(4)
    v_mfma_f32_32x32x16_bf16 v[48:63], a[24:27], a[120:123], v[48:63]
    v_lshlrev_b32 v38, 16, v75
    v_and_b32 v39, 0xffff0000, v75
    v_mul_f32 v32, v32, v40
    ds_read_b128 a[12:15], v6 offset:27648
    s_waitcnt lgkmcnt(4)
    v_mfma_f32_32x32x16_bf16 v[48:63], a[28:31], a[124:127], v[48:63]
    v_mul_f32 v33, v33, v41
    v_mul_f32 v34, v34, v42
    v_mul_f32 v35, v35, v43
    ds_read_b128 a[16:19], v6 offset:28672
    s_waitcnt lgkmcnt(4)
    v_mfma_f32_32x32x16_bf16 v[48:63], a[0:3], a[128:131], v[48:63]
    v_mul_f32 v36, v36, v44
    v_mul_f32 v37, v37, v45
    v_mul_f32 v38, v38, v46
    ds_read_b128 a[20:23], v6 offset:29696
    s_waitcnt lgkmcnt(4)
    v_mfma_f32_32x32x16_bf16 v[48:63], a[4:7], a[132:135], v[48:63]
    v_mul_f32 v39, v39, v47
    v_cvt_pk_bf16_f32 v68, v32, v33
    v_cvt_pk_bf16_f32 v69, v34, v35
    ds_read_b128 a[24:27], v6 offset:30720
    s_waitcnt lgkmcnt(4)
    v_mfma_f32_32x32x16_bf16 v[48:63], a[8:11], a[136:139], v[48:63]
    v_cvt_pk_bf16_f32 v70, v36, v37
    v_cvt_pk_bf16_f32 v71, v38, v39
    buffer_store_dwordx4 v[68:71], v83, s[8:11], 0 offen sc1
    ds_read_b128 a[28:31], v6 offset:31744
    s_waitcnt lgkmcnt(4)
    v_mfma_f32_32x32x16_bf16 v[48:63], a[12:15], a[140:143], v[48:63]
    s_barrier
    ds_read_b128 a[0:3], v6 offset:32768
    s_waitcnt lgkmcnt(4)
    v_mfma_f32_32x32x16_bf16 v[48:63], a[16:19], a[144:147], v[48:63]
    ds_read_b128 a[4:7], v6 offset:33792
    s_waitcnt lgkmcnt(4)
    v_mfma_f32_32x32x16_bf16 v[48:63], a[20:23], a[148:151], v[48:63]
    ds_read_b128 a[8:11], v6 offset:34816
    s_waitcnt lgkmcnt(4)
    v_mfma_f32_32x32x16_bf16 v[48:63], a[24:27], a[152:155], v[48:63]
    ds_read_b128 a[12:15], v6 offset:35840
    s_waitcnt lgkmcnt(4)
    v_mfma_f32_32x32x16_bf16 v[48:63], a[28:31], a[156:159], v[48:63]
    ds_read_b128 a[16:19], v6 offset:36864
    s_waitcnt lgkmcnt(4)
    v_mfma_f32_32x32x16_bf16 v[32:47], a[0:3], a[32:35], 0
    ds_read_b128 a[20:23], v6 offset:37888
    s_waitcnt lgkmcnt(4)
    v_mfma_f32_32x32x16_bf16 v[32:47], a[4:7], a[36:39], v[32:47]
    ds_read_b128 a[24:27], v6 offset:38912
    s_waitcnt lgkmcnt(4)
    v_mfma_f32_32x32x16_bf16 v[32:47], a[8:11], a[40:43], v[32:47]
    s_nop 2
    v_cvt_pk_bf16_f32 v72, v48, v49
    v_cvt_pk_bf16_f32 v76, v56, v57
    v_cvt_pk_bf16_f32 v73, v50, v51
    v_cvt_pk_bf16_f32 v77, v58, v59
    ds_read_b128 a[28:31], v6 offset:39936
    s_waitcnt lgkmcnt(4)
    v_mfma_f32_32x32x16_bf16 v[32:47], a[12:15], a[44:47], v[32:47]
    v_cvt_pk_bf16_f32 v74, v52, v53
    v_cvt_pk_bf16_f32 v78, v60, v61
    v_cvt_pk_bf16_f32 v75, v54, v55
    v_cvt_pk_bf16_f32 v79, v62, v63
    ds_read_b128 a[0:3], v6 offset:40960
    s_waitcnt lgkmcnt(4)
    v_mfma_f32_32x32x16_bf16 v[32:47], a[16:19], a[48:51], v[32:47]
    v_lshlrev_b32 v48, 16, v72
    v_and_b32 v49, 0xffff0000, v72
    v_lshlrev_b32 v50, 16, v73
    v_and_b32 v51, 0xffff0000, v73
    ds_read_b128 a[4:7], v6 offset:41984
    s_waitcnt lgkmcnt(4)
    v_mfma_f32_32x32x16_bf16 v[32:47], a[20:23], a[52:55], v[32:47]
    v_lshlrev_b32 v52, 16, v74
    v_and_b32 v53, 0xffff0000, v74
    v_lshlrev_b32 v54, 16, v75
    v_and_b32 v55, 0xffff0000, v75
    ds_read_b128 a[8:11], v6 offset:43008
    s_waitcnt lgkmcnt(4)
    v_mfma_f32_32x32x16_bf16 v[32:47], a[24:27], a[56:59], v[32:47]
    v_mul_f32 v48, 0xbfb8aa3b, v48
    v_mul_f32 v49, 0xbfb8aa3b, v49
    v_mul_f32 v50, 0xbfb8aa3b, v50
    v_mul_f32 v51, 0xbfb8aa3b, v51
    ds_read_b128 a[12:15], v6 offset:44032
    s_waitcnt lgkmcnt(4)
    v_mfma_f32_32x32x16_bf16 v[32:47], a[28:31], a[60:63], v[32:47]
    v_mul_f32 v52, 0xbfb8aa3b, v52
    v_mul_f32 v53, 0xbfb8aa3b, v53
    v_mul_f32 v54, 0xbfb8aa3b, v54
    v_mul_f32 v55, 0xbfb8aa3b, v55
    ds_read_b128 a[16:19], v6 offset:45056
    s_waitcnt lgkmcnt(4)
    v_mfma_f32_32x32x16_bf16 v[32:47], a[0:3], a[64:67], v[32:47]
    v_exp_f32 v48, v48
    v_lshlrev_b32 v56, 16, v76
    v_exp_f32 v49, v49
    v_and_b32 v57, 0xffff0000, v76
    ds_read_b128 a[20:23], v6 offset:46080
    s_waitcnt lgkmcnt(4)
    v_mfma_f32_32x32x16_bf16 v[32:47], a[4:7], a[68:71], v[32:47]
    v_exp_f32 v50, v50
    v_lshlrev_b32 v58, 16, v77
    v_exp_f32 v51, v51
    v_and_b32 v59, 0xffff0000, v77
    ds_read_b128 a[24:27], v6 offset:47104
    s_waitcnt lgkmcnt(4)
    v_mfma_f32_32x32x16_bf16 v[32:47], a[8:11], a[72:75], v[32:47]
    v_exp_f32 v52, v52
    v_lshlrev_b32 v60, 16, v78
    v_exp_f32 v53, v53
    v_and_b32 v61, 0xffff0000, v78
    ds_read_b128 a[28:31], v6 offset:48128
    s_waitcnt lgkmcnt(4)
    v_mfma_f32_32x32x16_bf16 v[32:47], a[12:15], a[76:79], v[32:47]
    v_exp_f32 v54, v54
    v_lshlrev_b32 v62, 16, v79
    v_exp_f32 v55, v55
    v_and_b32 v63, 0xffff0000, v79
    ds_read_b128 a[0:3], v6 offset:49152
    s_waitcnt lgkmcnt(4)
    v_mfma_f32_32x32x16_bf16 v[32:47], a[16:19], a[80:83], v[32:47]
    v_add_f32 v48, 1.0, v48
    v_add_f32 v49, 1.0, v49
    v_add_f32 v50, 1.0, v50
    v_add_f32 v51, 1.0, v51
    ds_read_b128 a[4:7], v6 offset:50176
    s_waitcnt lgkmcnt(4)
    v_mfma_f32_32x32x16_bf16 v[32:47], a[20:23], a[84:87], v[32:47]
    v_add_f32 v52, 1.0, v52
    v_add_f32 v53, 1.0, v53
    v_add_f32 v54, 1.0, v54
    ds_read_b128 a[8:11], v6 offset:51200
    s_waitcnt lgkmcnt(4)
    v_mfma_f32_32x32x16_bf16 v[32:47], a[24:27], a[88:91], v[32:47]
    v_add_f32 v55, 1.0, v55
    v_rcp_f32 v48, v48
    v_rcp_f32 v49, v49
    ds_read_b128 a[12:15], v6 offset:52224
    s_waitcnt lgkmcnt(4)
    v_mfma_f32_32x32x16_bf16 v[32:47], a[28:31], a[92:95], v[32:47]
    v_rcp_f32 v50, v50
    v_rcp_f32 v51, v51
    v_rcp_f32 v52, v52
    ds_read_b128 a[16:19], v6 offset:53248
    s_waitcnt lgkmcnt(4)
    v_mfma_f32_32x32x16_bf16 v[32:47], a[0:3], a[96:99], v[32:47]
    v_rcp_f32 v53, v53
    v_rcp_f32 v54, v54
    v_rcp_f32 v55, v55
    ds_read_b128 a[20:23], v6 offset:54272
    s_waitcnt lgkmcnt(4)
    v_mfma_f32_32x32x16_bf16 v[32:47], a[4:7], a[100:103], v[32:47]
    v_add_u32 v80, 8, v8
    v_lshrrev_b32 v81, 2, v80
    v_and_b32 v80, 3, v80
    ds_read_b128 a[24:27], v6 offset:55296
    s_waitcnt lgkmcnt(4)
    v_mfma_f32_32x32x16_bf16 v[32:47], a[8:11], a[104:107], v[32:47]
    v_lshl_add_u32 v81, v81, 12, v2
    v_lshl_add_u32 v82, v80, 8, v81
    v_cvt_pk_bf16_f32 v72, v48, v49
    ds_read_b128 a[28:31], v6 offset:56320
    s_waitcnt lgkmcnt(4)
    v_mfma_f32_32x32x16_bf16 v[32:47], a[12:15], a[108:111], v[32:47]
    v_cvt_pk_bf16_f32 v73, v50, v51
    v_cvt_pk_bf16_f32 v74, v52, v53
    v_cvt_pk_bf16_f32 v75, v54, v55
    ds_read_b128 a[0:3], v6 offset:57344
    s_waitcnt lgkmcnt(4)
    v_mfma_f32_32x32x16_bf16 v[32:47], a[16:19], a[112:115], v[32:47]
    v_lshlrev_b32 v48, 16, v72
    v_and_b32 v49, 0xffff0000, v72
    v_lshlrev_b32 v50, 16, v73
    ds_read_b128 a[4:7], v6 offset:58368
    s_waitcnt lgkmcnt(4)
    v_mfma_f32_32x32x16_bf16 v[32:47], a[20:23], a[116:119], v[32:47]
    v_and_b32 v51, 0xffff0000, v73
    v_lshlrev_b32 v52, 16, v74
    v_and_b32 v53, 0xffff0000, v74
    ds_read_b128 a[8:11], v6 offset:59392
    s_waitcnt lgkmcnt(4)
    v_mfma_f32_32x32x16_bf16 v[32:47], a[24:27], a[120:123], v[32:47]
    v_lshlrev_b32 v54, 16, v75
    v_and_b32 v55, 0xffff0000, v75
    v_mul_f32 v48, v48, v56
    ds_read_b128 a[12:15], v6 offset:60416
    s_waitcnt lgkmcnt(4)
    v_mfma_f32_32x32x16_bf16 v[32:47], a[28:31], a[124:127], v[32:47]
    v_mul_f32 v49, v49, v57
    v_mul_f32 v50, v50, v58
    v_mul_f32 v51, v51, v59
    ds_read_b128 a[16:19], v6 offset:61440
    s_waitcnt lgkmcnt(4)
    v_mfma_f32_32x32x16_bf16 v[32:47], a[0:3], a[128:131], v[32:47]
    v_mul_f32 v52, v52, v60
    v_mul_f32 v53, v53, v61
    v_mul_f32 v54, v54, v62
    ds_read_b128 a[20:23], v6 offset:62464
    s_waitcnt lgkmcnt(4)
    v_mfma_f32_32x32x16_bf16 v[32:47], a[4:7], a[132:135], v[32:47]
    v_mul_f32 v55, v55, v63
    v_cvt_pk_bf16_f32 v64, v48, v49
    v_cvt_pk_bf16_f32 v65, v50, v51
    ds_read_b128 a[24:27], v6 offset:63488
    s_waitcnt lgkmcnt(4)
    v_mfma_f32_32x32x16_bf16 v[32:47], a[8:11], a[136:139], v[32:47]
    v_cvt_pk_bf16_f32 v66, v52, v53
    v_cvt_pk_bf16_f32 v67, v54, v55
    buffer_store_dwordx4 v[64:67], v82, s[8:11], 0 offen sc1
    ds_read_b128 a[28:31], v6 offset:64512
    s_waitcnt lgkmcnt(4)
    v_mfma_f32_32x32x16_bf16 v[32:47], a[12:15], a[140:143], v[32:47]
    s_barrier
    ds_read_b128 a[0:3], v5 offset:0
    s_waitcnt lgkmcnt(4)
    v_mfma_f32_32x32x16_bf16 v[32:47], a[16:19], a[144:147], v[32:47]
    ds_read_b128 a[4:7], v5 offset:1024
    s_waitcnt lgkmcnt(4)
    v_mfma_f32_32x32x16_bf16 v[32:47], a[20:23], a[148:151], v[32:47]
    ds_read_b128 a[8:11], v5 offset:2048
    s_waitcnt lgkmcnt(4)
    v_mfma_f32_32x32x16_bf16 v[32:47], a[24:27], a[152:155], v[32:47]
    ds_read_b128 a[12:15], v5 offset:3072
    s_waitcnt lgkmcnt(4)
    v_mfma_f32_32x32x16_bf16 v[32:47], a[28:31], a[156:159], v[32:47]
    ds_read_b128 a[16:19], v5 offset:4096
    s_waitcnt lgkmcnt(4)
    v_mfma_f32_32x32x16_bf16 v[48:63], a[0:3], a[32:35], 0
    ds_read_b128 a[20:23], v5 offset:5120
    s_waitcnt lgkmcnt(4)
    v_mfma_f32_32x32x16_bf16 v[48:63], a[4:7], a[36:39], v[48:63]
    ds_read_b128 a[24:27], v5 offset:6144
    s_waitcnt lgkmcnt(4)
    v_mfma_f32_32x32x16_bf16 v[48:63], a[8:11], a[40:43], v[48:63]
    s_nop 2
    v_cvt_pk_bf16_f32 v72, v32, v33
    v_cvt_pk_bf16_f32 v76, v40, v41
    v_cvt_pk_bf16_f32 v73, v34, v35
    v_cvt_pk_bf16_f32 v77, v42, v43
    ds_read_b128 a[28:31], v5 offset:7168
    s_waitcnt lgkmcnt(4)
    v_mfma_f32_32x32x16_bf16 v[48:63], a[12:15], a[44:47], v[48:63]
    v_cvt_pk_bf16_f32 v74, v36, v37
    v_cvt_pk_bf16_f32 v78, v44, v45
    v_cvt_pk_bf16_f32 v75, v38, v39
    v_cvt_pk_bf16_f32 v79, v46, v47
    ds_read_b128 a[0:3], v5 offset:8192
    s_waitcnt lgkmcnt(4)
    v_mfma_f32_32x32x16_bf16 v[48:63], a[16:19], a[48:51], v[48:63]
    v_lshlrev_b32 v32, 16, v72
    v_and_b32 v33, 0xffff0000, v72
    v_lshlrev_b32 v34, 16, v73
    v_and_b32 v35, 0xffff0000, v73
    ds_read_b128 a[4:7], v5 offset:9216
    s_waitcnt lgkmcnt(4)
    v_mfma_f32_32x32x16_bf16 v[48:63], a[20:23], a[52:55], v[48:63]
    v_lshlrev_b32 v36, 16, v74
    v_and_b32 v37, 0xffff0000, v74
    v_lshlrev_b32 v38, 16, v75
    v_and_b32 v39, 0xffff0000, v75
    ds_read_b128 a[8:11], v5 offset:10240
    s_waitcnt lgkmcnt(4)
    v_mfma_f32_32x32x16_bf16 v[48:63], a[24:27], a[56:59], v[48:63]
    v_mul_f32 v32, 0xbfb8aa3b, v32
    v_mul_f32 v33, 0xbfb8aa3b, v33
    v_mul_f32 v34, 0xbfb8aa3b, v34
    v_mul_f32 v35, 0xbfb8aa3b, v35
    ds_read_b128 a[12:15], v5 offset:11264
    s_waitcnt lgkmcnt(4)
    v_mfma_f32_32x32x16_bf16 v[48:63], a[28:31], a[60:63], v[48:63]
    v_mul_f32 v36, 0xbfb8aa3b, v36
    v_mul_f32 v37, 0xbfb8aa3b, v37
    v_mul_f32 v38, 0xbfb8aa3b, v38
    v_mul_f32 v39, 0xbfb8aa3b, v39
    ds_read_b128 a[16:19], v5 offset:12288
    s_waitcnt lgkmcnt(4)
    v_mfma_f32_32x32x16_bf16 v[48:63], a[0:3], a[64:67], v[48:63]
    v_exp_f32 v32, v32
    v_lshlrev_b32 v40, 16, v76
    v_exp_f32 v33, v33
    v_and_b32 v41, 0xffff0000, v76
    ds_read_b128 a[20:23], v5 offset:13312
    s_waitcnt lgkmcnt(4)
    v_mfma_f32_32x32x16_bf16 v[48:63], a[4:7], a[68:71], v[48:63]
    v_exp_f32 v34, v34
    v_lshlrev_b32 v42, 16, v77
    v_exp_f32 v35, v35
    v_and_b32 v43, 0xffff0000, v77
    ds_read_b128 a[24:27], v5 offset:14336
    s_waitcnt lgkmcnt(4)
    v_mfma_f32_32x32x16_bf16 v[48:63], a[8:11], a[72:75], v[48:63]
    v_exp_f32 v36, v36
    v_lshlrev_b32 v44, 16, v78
    v_exp_f32 v37, v37
    v_and_b32 v45, 0xffff0000, v78
    ds_read_b128 a[28:31], v5 offset:15360
    s_waitcnt lgkmcnt(4)
    v_mfma_f32_32x32x16_bf16 v[48:63], a[12:15], a[76:79], v[48:63]
    v_exp_f32 v38, v38
    v_lshlrev_b32 v46, 16, v79
    v_exp_f32 v39, v39
    v_and_b32 v47, 0xffff0000, v79
    ds_read_b128 a[0:3], v5 offset:16384
    s_waitcnt lgkmcnt(4)
    v_mfma_f32_32x32x16_bf16 v[48:63], a[16:19], a[80:83], v[48:63]
    v_add_f32 v32, 1.0, v32
    v_add_f32 v33, 1.0, v33
    v_add_f32 v34, 1.0, v34
    v_add_f32 v35, 1.0, v35
    ds_read_b128 a[4:7], v5 offset:17408
    s_waitcnt lgkmcnt(4)
    v_mfma_f32_32x32x16_bf16 v[48:63], a[20:23], a[84:87], v[48:63]
    v_add_f32 v36, 1.0, v36
    v_add_f32 v37, 1.0, v37
    v_add_f32 v38, 1.0, v38
    ds_read_b128 a[8:11], v5 offset:18432
    s_waitcnt lgkmcnt(4)
    v_mfma_f32_32x32x16_bf16 v[48:63], a[24:27], a[88:91], v[48:63]
    v_add_f32 v39, 1.0, v39
    v_rcp_f32 v32, v32
    v_rcp_f32 v33, v33
    ds_read_b128 a[12:15], v5 offset:19456
    s_waitcnt lgkmcnt(4)
    v_mfma_f32_32x32x16_bf16 v[48:63], a[28:31], a[92:95], v[48:63]
    v_rcp_f32 v34, v34
    v_rcp_f32 v35, v35
    v_rcp_f32 v36, v36
    ds_read_b128 a[16:19], v5 offset:20480
    s_waitcnt lgkmcnt(4)
    v_mfma_f32_32x32x16_bf16 v[48:63], a[0:3], a[96:99], v[48:63]
    v_rcp_f32 v37, v37
    v_rcp_f32 v38, v38
    v_rcp_f32 v39, v39
    ds_read_b128 a[20:23], v5 offset:21504
    s_waitcnt lgkmcnt(4)
    v_mfma_f32_32x32x16_bf16 v[48:63], a[4:7], a[100:103], v[48:63]
    v_add_u32 v80, 10, v8
    v_lshrrev_b32 v81, 2, v80
    v_and_b32 v80, 3, v80
    ds_read_b128 a[24:27], v5 offset:22528
    s_waitcnt lgkmcnt(4)
    v_mfma_f32_32x32x16_bf16 v[48:63], a[8:11], a[104:107], v[48:63]
    v_lshl_add_u32 v81, v81, 12, v2
    v_lshl_add_u32 v83, v80, 8, v81
    v_cvt_pk_bf16_f32 v72, v32, v33
    ds_read_b128 a[28:31], v5 offset:23552
    s_waitcnt lgkmcnt(4)
    v_mfma_f32_32x32x16_bf16 v[48:63], a[12:15], a[108:111], v[48:63]
    v_cvt_pk_bf16_f32 v73, v34, v35
    v_cvt_pk_bf16_f32 v74, v36, v37
    v_cvt_pk_bf16_f32 v75, v38, v39
    ds_read_b128 a[0:3], v5 offset:24576
    s_waitcnt lgkmcnt(4)
    v_mfma_f32_32x32x16_bf16 v[48:63], a[16:19], a[112:115], v[48:63]
    v_lshlrev_b32 v32, 16, v72
    v_and_b32 v33, 0xffff0000, v72
    v_lshlrev_b32 v34, 16, v73
    ds_read_b128 a[4:7], v5 offset:25600
    s_waitcnt lgkmcnt(4)
    v_mfma_f32_32x32x16_bf16 v[48:63], a[20:23], a[116:119], v[48:63]
    v_and_b32 v35, 0xffff0000, v73
    v_lshlrev_b32 v36, 16, v74
    v_and_b32 v37, 0xffff0000, v74
    ds_read_b128 a[8:11], v5 offset:26624
    s_waitcnt lgkmcnt(4)
    v_mfma_f32_32x32x16_bf16 v[48:63], a[24:27], a[120:123], v[48:63]
    v_lshlrev_b32 v38, 16, v75
    v_and_b32 v39, 0xffff0000, v75
    v_mul_f32 v32, v32, v40
    ds_read_b128 a[12:15], v5 offset:27648
    s_waitcnt lgkmcnt(4)
    v_mfma_f32_32x32x16_bf16 v[48:63], a[28:31], a[124:127], v[48:63]
    v_mul_f32 v33, v33, v41
    v_mul_f32 v34, v34, v42
    v_mul_f32 v35, v35, v43
    ds_read_b128 a[16:19], v5 offset:28672
    s_waitcnt lgkmcnt(4)
    v_mfma_f32_32x32x16_bf16 v[48:63], a[0:3], a[128:131], v[48:63]
    v_mul_f32 v36, v36, v44
    v_mul_f32 v37, v37, v45
    v_mul_f32 v38, v38, v46
    ds_read_b128 a[20:23], v5 offset:29696
    s_waitcnt lgkmcnt(4)
    v_mfma_f32_32x32x16_bf16 v[48:63], a[4:7], a[132:135], v[48:63]
    v_mul_f32 v39, v39, v47
    v_cvt_pk_bf16_f32 v68, v32, v33
    v_cvt_pk_bf16_f32 v69, v34, v35
    ds_read_b128 a[24:27], v5 offset:30720
    s_waitcnt lgkmcnt(4)
    v_mfma_f32_32x32x16_bf16 v[48:63], a[8:11], a[136:139], v[48:63]
    v_cvt_pk_bf16_f32 v70, v36, v37
    v_cvt_pk_bf16_f32 v71, v38, v39
    buffer_store_dwordx4 v[68:71], v83, s[8:11], 0 offen sc1
    ds_read_b128 a[28:31], v5 offset:31744
    s_waitcnt lgkmcnt(4)
    v_mfma_f32_32x32x16_bf16 v[48:63], a[12:15], a[140:143], v[48:63]
    s_waitcnt lgkmcnt(3)
    v_mfma_f32_32x32x16_bf16 v[48:63], a[16:19], a[144:147], v[48:63]
    s_waitcnt lgkmcnt(2)
    v_mfma_f32_32x32x16_bf16 v[48:63], a[20:23], a[148:151], v[48:63]
    s_waitcnt lgkmcnt(1)
    v_mfma_f32_32x32x16_bf16 v[48:63], a[24:27], a[152:155], v[48:63]
    s_waitcnt lgkmcnt(0)
    v_mfma_f32_32x32x16_bf16 v[48:63], a[28:31], a[156:159], v[48:63]
    s_nop 11
    v_cvt_pk_bf16_f32 v72, v48, v49
    v_cvt_pk_bf16_f32 v76, v56, v57
    v_cvt_pk_bf16_f32 v73, v50, v51
    v_cvt_pk_bf16_f32 v77, v58, v59
    v_cvt_pk_bf16_f32 v74, v52, v53
    v_cvt_pk_bf16_f32 v78, v60, v61
    v_cvt_pk_bf16_f32 v75, v54, v55
    v_cvt_pk_bf16_f32 v79, v62, v63
    v_lshlrev_b32 v48, 16, v72
    v_and_b32 v49, 0xffff0000, v72
    v_lshlrev_b32 v50, 16, v73
    v_and_b32 v51, 0xffff0000, v73
    v_lshlrev_b32 v52, 16, v74
    v_and_b32 v53, 0xffff0000, v74
    v_lshlrev_b32 v54, 16, v75
    v_and_b32 v55, 0xffff0000, v75
    v_mul_f32 v48, 0xbfb8aa3b, v48
    v_mul_f32 v49, 0xbfb8aa3b, v49
    v_mul_f32 v50, 0xbfb8aa3b, v50
    v_mul_f32 v51, 0xbfb8aa3b, v51
    v_mul_f32 v52, 0xbfb8aa3b, v52
    v_mul_f32 v53, 0xbfb8aa3b, v53
    v_mul_f32 v54, 0xbfb8aa3b, v54
    v_mul_f32 v55, 0xbfb8aa3b, v55
    v_exp_f32 v48, v48
    v_lshlrev_b32 v56, 16, v76
    v_exp_f32 v49, v49
    v_and_b32 v57, 0xffff0000, v76
    v_exp_f32 v50, v50
    v_lshlrev_b32 v58, 16, v77
    v_exp_f32 v51, v51
    v_and_b32 v59, 0xffff0000, v77
    v_exp_f32 v52, v52
    v_lshlrev_b32 v60, 16, v78
    v_exp_f32 v53, v53
    v_and_b32 v61, 0xffff0000, v78
    v_exp_f32 v54, v54
    v_lshlrev_b32 v62, 16, v79
    v_exp_f32 v55, v55
    v_and_b32 v63, 0xffff0000, v79
    v_add_f32 v48, 1.0, v48
    v_add_f32 v49, 1.0, v49
    v_add_f32 v50, 1.0, v50
    v_add_f32 v51, 1.0, v51
    v_add_f32 v52, 1.0, v52
    v_add_f32 v53, 1.0, v53
    v_add_f32 v54, 1.0, v54
    v_add_f32 v55, 1.0, v55
    v_rcp_f32 v48, v48
    v_rcp_f32 v49, v49
    v_rcp_f32 v50, v50
    v_rcp_f32 v51, v51
    v_rcp_f32 v52, v52
    v_rcp_f32 v53, v53
    v_rcp_f32 v54, v54
    v_rcp_f32 v55, v55
    v_add_u32 v80, 12, v8
    v_lshrrev_b32 v81, 2, v80
    v_and_b32 v80, 3, v80
    v_lshl_add_u32 v81, v81, 12, v2
    v_lshl_add_u32 v82, v80, 8, v81
    v_cvt_pk_bf16_f32 v72, v48, v49
    v_cvt_pk_bf16_f32 v73, v50, v51
    v_cvt_pk_bf16_f32 v74, v52, v53
    v_cvt_pk_bf16_f32 v75, v54, v55
    v_lshlrev_b32 v48, 16, v72
    v_and_b32 v49, 0xffff0000, v72
    v_lshlrev_b32 v50, 16, v73
    v_and_b32 v51, 0xffff0000, v73
    v_lshlrev_b32 v52, 16, v74
    v_and_b32 v53, 0xffff0000, v74
    v_lshlrev_b32 v54, 16, v75
    v_and_b32 v55, 0xffff0000, v75
    v_mul_f32 v48, v48, v56
    v_mul_f32 v49, v49, v57
    v_mul_f32 v50, v50, v58
    v_mul_f32 v51, v51, v59
    v_mul_f32 v52, v52, v60
    v_mul_f32 v53, v53, v61
    v_mul_f32 v54, v54, v62
    v_mul_f32 v55, v55, v63
    v_cvt_pk_bf16_f32 v64, v48, v49
    v_cvt_pk_bf16_f32 v65, v50, v51
    v_cvt_pk_bf16_f32 v66, v52, v53
    v_cvt_pk_bf16_f32 v67, v54, v55
    buffer_store_dwordx4 v[64:67], v82, s[8:11], 0 offen sc1
K1_END:
    s_endpgm

.globl ssm_k2_kernel
.p2align 8
.type ssm_k2_kernel,@function
ssm_k2_kernel:
    s_cmp_ge_u32 s2, 256
    s_cbranch_scc1 K2_END
    s_load_dwordx16 s[64:79], s[0:1], 0
    s_load_dwordx16 s[80:95], s[0:1], 64
    v_and_b32 v1, 63, v0
    v_lshrrev_b32 v2, 6, v0
    s_nop 0
    v_readfirstlane_b32 s42, v2
    s_and_b32 s3, s2, 7
    s_lshr_b32 s4, s2, 3
    s_and_b32 s41, s4, 7
    s_lshr_b32 s4, s4, 3
    s_lshl_b32 s3, s3, 2
    s_add_u32 s40, s3, s4
    v_lshlrev_b32 v6, 4, v1
    s_mul_i32 s44, s40, 360448
    s_add_u32 s44, s44, 10485760
    s_mul_i32 s45, s41, 360448
    s_add_u32 s45, s45, 7340032
    s_lshl_b32 s3, s42, 15
    s_add_u32 s46, s44, s3
    s_add_u32 s47, s45, s3
    s_mul_i32 s3, s42, 57344
    s_add_u32 s3, s3, 131072
    s_add_u32 s48, s44, s3
    s_add_u32 s49, s45, s3
    s_waitcnt lgkmcnt(0)
    s_mov_b32 s8, s94
    s_and_b32 s9, s95, 0xffff
    s_mov_b32 s10, 33554432
    s_mov_b32 s11, 0x00020000
    s_add_u32 s7, s47, 0
    s_add_u32 s20, s46, 0
    buffer_load_dwordx4 v[32:35], v6, s[8:11], s7 offen offset:0
    buffer_load_dwordx4 v[48:51], v6, s[8:11], s20 offen offset:0
    buffer_load_dwordx4 v[36:39], v6, s[8:11], s7 offen offset:1024
    buffer_load_dwordx4 v[52:55], v6, s[8:11], s20 offen offset:1024
    buffer_load_dwordx4 v[40:43], v6, s[8:11], s7 offen offset:2048
    buffer_load_dwordx4 v[56:59], v6, s[8:11], s20 offen offset:2048
    buffer_load_dwordx4 v[44:47], v6, s[8:11], s7 offen offset:3072
    buffer_load_dwordx4 v[60:63], v6, s[8:11], s20 offen offset:3072
    s_add_u32 s7, s47, 4096
    s_add_u32 s20, s46, 4096
    buffer_load_dwordx4 v[64:67], v6, s[8:11], s7 offen offset:0
    buffer_load_dwordx4 v[80:83], v6, s[8:11], s20 offen offset:0
    buffer_load_dwordx4 v[68:71], v6, s[8:11], s7 offen offset:1024
    buffer_load_dwordx4 v[84:87], v6, s[8:11], s20 offen offset:1024
    buffer_load_dwordx4 v[72:75], v6, s[8:11], s7 offen offset:2048
    buffer_load_dwordx4 v[88:91], v6, s[8:11], s20 offen offset:2048
    buffer_load_dwordx4 v[76:79], v6, s[8:11], s7 offen offset:3072
    buffer_load_dwordx4 v[92:95], v6, s[8:11], s20 offen offset:3072
    s_add_u32 s7, s47, 8192
    s_add_u32 s20, s46, 8192
    buffer_load_dwordx4 v[96:99], v6, s[8:11], s7 offen offset:0
    buffer_load_dwordx4 v[112:115], v6, s[8:11], s20 offen offset:0
    buffer_load_dwordx4 v[100:103], v6, s[8:11], s7 offen offset:1024
    buffer_load_dwordx4 v[116:119], v6, s[8:11], s20 offen offset:1024
    buffer_load_dwordx4 v[104:107], v6, s[8:11], s7 offen offset:2048
    buffer_load_dwordx4 v[120:123], v6, s[8:11], s20 offen offset:2048
    buffer_load_dwordx4 v[108:111], v6, s[8:11], s7 offen offset:3072
    buffer_load_dwordx4 v[124:127], v6, s[8:11], s20 offen offset:3072
    s_add_u32 s7, s47, 12288
    s_add_u32 s20, s46, 12288
    buffer_load_dwordx4 v[128:131], v6, s[8:11], s7 offen offset:0
    buffer_load_dwordx4 v[144:147], v6, s[8:11], s20 offen offset:0
    buffer_load_dwordx4 v[132:135], v6, s[8:11], s7 offen offset:1024
    buffer_load_dwordx4 v[148:151], v6, s[8:11], s20 offen offset:1024
    buffer_load_dwordx4 v[136:139], v6, s[8:11], s7 offen offset:2048
    buffer_load_dwordx4 v[152:155], v6, s[8:11], s20 offen offset:2048
    buffer_load_dwordx4 v[140:143], v6, s[8:11], s7 offen offset:3072
    buffer_load_dwordx4 v[156:159], v6, s[8:11], s20 offen offset:3072
    s_mov_b32 s24, s64
    s_and_b32 s25, s65, 0xffff
    s_mov_b32 s26, 2097152
    s_mov_b32 s27, 0x00020000
    s_mov_b32 s28, s80
    s_and_b32 s29, s81, 0xffff
    s_mov_b32 s30, 1024
    s_mov_b32 s31, 0x00020000
    s_mov_b32 s32, s90
    s_and_b32 s33, s91, 0xffff
    s_mov_b32 s34, 4194304
    s_mov_b32 s35, 0x00020000
    v_and_b32 v3, 15, v1
    v_lshrrev_b32 v4, 4, v1
    s_lshl_b32 s3, s40, 6
    s_lshl_b32 s4, s42, 4
    s_add_u32 s3, s3, s4
    v_add_u32 v8, s3, v3
    s_lshl_b32 s4, s41, 6
    v_lshl_add_u32 v14, v4, 2, s4
    v_lshlrev_b32 v11, 10, v8
    v_lshl_add_u32 v11, v14, 1, v11
    v_lshlrev_b32 v12, 1, v14
    v_lshlrev_b32 v13, 3, v8
    v_add_u32 v13, 22020096, v13
    s_lshl_b32 s3, s42, 12
    v_add_u32 v9, s3, v6
    v_add_u32 v10, 0x10000, v9
    s_lshl_b32 s3, s42, 14
    v_add_u32 v15, s3, v6
    v_add_u32 v16, 0x10000, v15
    s_add_u32 s7, s47, 16384
    s_add_u32 s20, s46, 16384
    buffer_load_dwordx4 v[160:163], v6, s[8:11], s7 offen offset:0
    buffer_load_dwordx4 v[176:179], v6, s[8:11], s20 offen offset:0
    buffer_load_dwordx4 v[164:167], v6, s[8:11], s7 offen offset:1024
    buffer_load_dwordx4 v[180:183], v6, s[8:11], s20 offen offset:1024
    buffer_load_dwordx4 v[168:171], v6, s[8:11], s7 offen offset:2048
    buffer_load_dwordx4 v[184:187], v6, s[8:11], s20 offen offset:2048
    buffer_load_dwordx4 v[172:175], v6, s[8:11], s7 offen offset:3072
    buffer_load_dwordx4 v[188:191], v6, s[8:11], s20 offen offset:3072
    buffer_load_dwordx2 v[224:225], v11, s[24:27], 0 offen offset:0
    buffer_load_dwordx2 v[232:233], v12, s[28:31], 0 offen offset:0
    buffer_load_dwordx2 v[226:227], v11, s[24:27], 0 offen offset:32
    buffer_load_dwordx2 v[234:235], v12, s[28:31], 0 offen offset:32
    buffer_load_dwordx2 v[228:229], v11, s[24:27], 0 offen offset:64
    buffer_load_dwordx2 v[236:237], v12, s[28:31], 0 offen offset:64
    buffer_load_dwordx2 v[230:231], v11, s[24:27], 0 offen offset:96
    buffer_load_dwordx2 v[238:239], v12, s[28:31], 0 offen offset:96
    buffer_load_dwordx2 v[240:241], v13, s[8:11], 0 offen
    s_waitcnt vmcnt(41)
    v_mfma_f32_16x16x32_bf16 a[0:3], v[32:35], v[48:51], 0
    v_mfma_f32_16x16x32_bf16 a[4:7], v[36:39], v[48:51], 0
    v_mfma_f32_16x16x32_bf16 a[8:11], v[40:43], v[48:51], 0
    v_mfma_f32_16x16x32_bf16 a[12:15], v[44:47], v[48:51], 0
    v_mfma_f32_16x16x32_bf16 a[16:19], v[32:35], v[52:55], 0
    v_mfma_f32_16x16x32_bf16 a[20:23], v[36:39], v[52:55], 0
    v_mfma_f32_16x16x32_bf16 a[24:27], v[40:43], v[52:55], 0
    v_mfma_f32_16x16x32_bf16 a[28:31], v[44:47], v[52:55], 0
    v_mfma_f32_16x16x32_bf16 a[32:35], v[32:35], v[56:59], 0
    v_mfma_f32_16x16x32_bf16 a[36:39], v[36:39], v[56:59], 0
    v_mfma_f32_16x16x32_bf16 a[40:43], v[40:43], v[56:59], 0
    v_mfma_f32_16x16x32_bf16 a[44:47], v[44:47], v[56:59], 0
    v_mfma_f32_16x16x32_bf16 a[48:51], v[32:35], v[60:63], 0
    v_mfma_f32_16x16x32_bf16 a[52:55], v[36:39], v[60:63], 0
    v_mfma_f32_16x16x32_bf16 a[56:59], v[40:43], v[60:63], 0
    v_mfma_f32_16x16x32_bf16 a[60:63], v[44:47], v[60:63], 0
    s_add_u32 s7, s47, 20480
    s_add_u32 s20, s46, 20480
    buffer_load_dwordx4 v[32:35], v6, s[8:11], s7 offen offset:0
    buffer_load_dwordx4 v[48:51], v6, s[8:11], s20 offen offset:0
    buffer_load_dwordx4 v[36:39], v6, s[8:11], s7 offen offset:1024
    buffer_load_dwordx4 v[52:55], v6, s[8:11], s20 offen offset:1024
    buffer_load_dwordx4 v[40:43], v6, s[8:11], s7 offen offset:2048
    buffer_load_dwordx4 v[56:59], v6, s[8:11], s20 offen offset:2048
    buffer_load_dwordx4 v[44:47], v6, s[8:11], s7 offen offset:3072
    buffer_load_dwordx4 v[60:63], v6, s[8:11], s20 offen offset:3072
    s_waitcnt vmcnt(41)
    v_mfma_f32_16x16x32_bf16 a[0:3], v[64:67], v[80:83], a[0:3]
    v_mfma_f32_16x16x32_bf16 a[4:7], v[68:71], v[80:83], a[4:7]
    v_mfma_f32_16x16x32_bf16 a[8:11], v[72:75], v[80:83], a[8:11]
    v_mfma_f32_16x16x32_bf16 a[12:15], v[76:79], v[80:83], a[12:15]
    v_mfma_f32_16x16x32_bf16 a[16:19], v[64:67], v[84:87], a[16:19]
    v_mfma_f32_16x16x32_bf16 a[20:23], v[68:71], v[84:87], a[20:23]
    v_mfma_f32_16x16x32_bf16 a[24:27], v[72:75], v[84:87], a[24:27]
    v_mfma_f32_16x16x32_bf16 a[28:31], v[76:79], v[84:87], a[28:31]
    v_mfma_f32_16x16x32_bf16 a[32:35], v[64:67], v[88:91], a[32:35]
    v_mfma_f32_16x16x32_bf16 a[36:39], v[68:71], v[88:91], a[36:39]
    v_mfma_f32_16x16x32_bf16 a[40:43], v[72:75], v[88:91], a[40:43]
    v_mfma_f32_16x16x32_bf16 a[44:47], v[76:79], v[88:91], a[44:47]
    v_mfma_f32_16x16x32_bf16 a[48:51], v[64:67], v[92:95], a[48:51]
    v_mfma_f32_16x16x32_bf16 a[52:55], v[68:71], v[92:95], a[52:55]
    v_mfma_f32_16x16x32_bf16 a[56:59], v[72:75], v[92:95], a[56:59]
    v_mfma_f32_16x16x32_bf16 a[60:63], v[76:79], v[92:95], a[60:63]
    s_add_u32 s7, s47, 24576
    s_add_u32 s20, s46, 24576
    buffer_load_dwordx4 v[64:67], v6, s[8:11], s7 offen offset:0
    buffer_load_dwordx4 v[80:83], v6, s[8:11], s20 offen offset:0
    buffer_load_dwordx4 v[68:71], v6, s[8:11], s7 offen offset:1024
    buffer_load_dwordx4 v[84:87], v6, s[8:11], s20 offen offset:1024
    buffer_load_dwordx4 v[72:75], v6, s[8:11], s7 offen offset:2048
    buffer_load_dwordx4 v[88:91], v6, s[8:11], s20 offen offset:2048
    buffer_load_dwordx4 v[76:79], v6, s[8:11], s7 offen offset:3072
    buffer_load_dwordx4 v[92:95], v6, s[8:11], s20 offen offset:3072
    s_waitcnt vmcnt(41)
    v_mfma_f32_16x16x32_bf16 a[0:3], v[96:99], v[112:115], a[0:3]
    v_mfma_f32_16x16x32_bf16 a[4:7], v[100:103], v[112:115], a[4:7]
    v_mfma_f32_16x16x32_bf16 a[8:11], v[104:107], v[112:115], a[8:11]
    v_mfma_f32_16x16x32_bf16 a[12:15], v[108:111], v[112:115], a[12:15]
    v_mfma_f32_16x16x32_bf16 a[16:19], v[96:99], v[116:119], a[16:19]
    v_mfma_f32_16x16x32_bf16 a[20:23], v[100:103], v[116:119], a[20:23]
    v_mfma_f32_16x16x32_bf16 a[24:27], v[104:107], v[116:119], a[24:27]
    v_mfma_f32_16x16x32_bf16 a[28:31], v[108:111], v[116:119], a[28:31]
    v_mfma_f32_16x16x32_bf16 a[32:35], v[96:99], v[120:123], a[32:35]
    v_mfma_f32_16x16x32_bf16 a[36:39], v[100:103], v[120:123], a[36:39]
    v_mfma_f32_16x16x32_bf16 a[40:43], v[104:107], v[120:123], a[40:43]
    v_mfma_f32_16x16x32_bf16 a[44:47], v[108:111], v[120:123], a[44:47]
    v_mfma_f32_16x16x32_bf16 a[48:51], v[96:99], v[124:127], a[48:51]
    v_mfma_f32_16x16x32_bf16 a[52:55], v[100:103], v[124:127], a[52:55]
    v_mfma_f32_16x16x32_bf16 a[56:59], v[104:107], v[124:127], a[56:59]
    v_mfma_f32_16x16x32_bf16 a[60:63], v[108:111], v[124:127], a[60:63]
    s_add_u32 s7, s47, 28672
    s_add_u32 s20, s46, 28672
    buffer_load_dwordx4 v[96:99], v6, s[8:11], s7 offen offset:0
    buffer_load_dwordx4 v[112:115], v6, s[8:11], s20 offen offset:0
    buffer_load_dwordx4 v[100:103], v6, s[8:11], s7 offen offset:1024
    buffer_load_dwordx4 v[116:119], v6, s[8:11], s20 offen offset:1024
    buffer_load_dwordx4 v[104:107], v6, s[8:11], s7 offen offset:2048
    buffer_load_dwordx4 v[120:123], v6, s[8:11], s20 offen offset:2048
    buffer_load_dwordx4 v[108:111], v6, s[8:11], s7 offen offset:3072
    buffer_load_dwordx4 v[124:127], v6, s[8:11], s20 offen offset:3072
    s_waitcnt vmcnt(41)
    v_mfma_f32_16x16x32_bf16 a[0:3], v[128:131], v[144:147], a[0:3]
    v_mfma_f32_16x16x32_bf16 a[4:7], v[132:135], v[144:147], a[4:7]
    v_mfma_f32_16x16x32_bf16 a[8:11], v[136:139], v[144:147], a[8:11]
    v_mfma_f32_16x16x32_bf16 a[12:15], v[140:143], v[144:147], a[12:15]
    v_mfma_f32_16x16x32_bf16 a[16:19], v[128:131], v[148:151], a[16:19]
    v_mfma_f32_16x16x32_bf16 a[20:23], v[132:135], v[148:151], a[20:23]
    v_mfma_f32_16x16x32_bf16 a[24:27], v[136:139], v[148:151], a[24:27]
    v_mfma_f32_16x16x32_bf16 a[28:31], v[140:143], v[148:151], a[28:31]
    v_mfma_f32_16x16x32_bf16 a[32:35], v[128:131], v[152:155], a[32:35]
    v_mfma_f32_16x16x32_bf16 a[36:39], v[132:135], v[152:155], a[36:39]
    v_mfma_f32_16x16x32_bf16 a[40:43], v[136:139], v[152:155], a[40:43]
    v_mfma_f32_16x16x32_bf16 a[44:47], v[140:143], v[152:155], a[44:47]
    v_mfma_f32_16x16x32_bf16 a[48:51], v[128:131], v[156:159], a[48:51]
    v_mfma_f32_16x16x32_bf16 a[52:55], v[132:135], v[156:159], a[52:55]
    v_mfma_f32_16x16x32_bf16 a[56:59], v[136:139], v[156:159], a[56:59]
    v_mfma_f32_16x16x32_bf16 a[60:63], v[140:143], v[156:159], a[60:63]
    s_add_u32 s7, s49, 0
    s_add_u32 s20, s48, 0
    buffer_load_dwordx4 v[128:131], v6, s[8:11], s7 offen offset:0
    buffer_load_dwordx4 v[144:147], v6, s[8:11], s20 offen offset:0
    buffer_load_dwordx4 v[132:135], v6, s[8:11], s7 offen offset:1024
    buffer_load_dwordx4 v[148:151], v6, s[8:11], s20 offen offset:1024
    buffer_load_dwordx4 v[136:139], v6, s[8:11], s7 offen offset:2048
    buffer_load_dwordx4 v[152:155], v6, s[8:11], s20 offen offset:2048
    buffer_load_dwordx4 v[140:143], v6, s[8:11], s7 offen offset:3072
    buffer_load_dwordx4 v[156:159], v6, s[8:11], s20 offen offset:3072
    s_waitcnt vmcnt(41)
    v_mfma_f32_16x16x32_bf16 a[0:3], v[160:163], v[176:179], a[0:3]
    v_mfma_f32_16x16x32_bf16 a[4:7], v[164:167], v[176:179], a[4:7]
    v_mfma_f32_16x16x32_bf16 a[8:11], v[168:171], v[176:179], a[8:11]
    v_mfma_f32_16x16x32_bf16 a[12:15], v[172:175], v[176:179], a[12:15]
    v_mfma_f32_16x16x32_bf16 a[16:19], v[160:163], v[180:183], a[16:19]
    v_mfma_f32_16x16x32_bf16 a[20:23], v[164:167], v[180:183], a[20:23]
    v_mfma_f32_16x16x32_bf16 a[24:27], v[168:171], v[180:183], a[24:27]
    v_mfma_f32_16x16x32_bf16 a[28:31], v[172:175], v[180:183], a[28:31]
    v_mfma_f32_16x16x32_bf16 a[32:35], v[160:163], v[184:187], a[32:35]
    v_mfma_f32_16x16x32_bf16 a[36:39], v[164:167], v[184:187], a[36:39]
    v_mfma_f32_16x16x32_bf16 a[40:43], v[168:171], v[184:187], a[40:43]
    v_mfma_f32_16x16x32_bf16 a[44:47], v[172:175], v[184:187], a[44:47]
    v_mfma_f32_16x16x32_bf16 a[48:51], v[160:163], v[188:191], a[48:51]
    v_mfma_f32_16x16x32_bf16 a[52:55], v[164:167], v[188:191], a[52:55]
    v_mfma_f32_16x16x32_bf16 a[56:59], v[168:171], v[188:191], a[56:59]
    v_mfma_f32_16x16x32_bf16 a[60:63], v[172:175], v[188:191], a[60:63]
    s_add_u32 s7, s49, 4096
    s_add_u32 s20, s48, 4096
    buffer_load_dwordx4 v[160:163], v6, s[8:11], s7 offen offset:0
    buffer_load_dwordx4 v[176:179], v6, s[8:11], s20 offen offset:0
    buffer_load_dwordx4 v[164:167], v6, s[8:11], s7 offen offset:1024
    buffer_load_dwordx4 v[180:183], v6, s[8:11], s20 offen offset:1024
    buffer_load_dwordx4 v[168:171], v6, s[8:11], s7 offen offset:2048
    buffer_load_dwordx4 v[184:187], v6, s[8:11], s20 offen offset:2048
    buffer_load_dwordx4 v[172:175], v6, s[8:11], s7 offen offset:3072
    buffer_load_dwordx4 v[188:191], v6, s[8:11], s20 offen offset:3072
    s_waitcnt vmcnt(32)
    v_mfma_f32_16x16x32_bf16 a[0:3], v[32:35], v[48:51], a[0:3]
    v_mfma_f32_16x16x32_bf16 a[4:7], v[36:39], v[48:51], a[4:7]
    v_mfma_f32_16x16x32_bf16 a[8:11], v[40:43], v[48:51], a[8:11]
    v_mfma_f32_16x16x32_bf16 a[12:15], v[44:47], v[48:51], a[12:15]
    v_mfma_f32_16x16x32_bf16 a[16:19], v[32:35], v[52:55], a[16:19]
    v_mfma_f32_16x16x32_bf16 a[20:23], v[36:39], v[52:55], a[20:23]
    v_mfma_f32_16x16x32_bf16 a[24:27], v[40:43], v[52:55], a[24:27]
    v_mfma_f32_16x16x32_bf16 a[28:31], v[44:47], v[52:55], a[28:31]
    v_mfma_f32_16x16x32_bf16 a[32:35], v[32:35], v[56:59], a[32:35]
    v_mfma_f32_16x16x32_bf16 a[36:39], v[36:39], v[56:59], a[36:39]
    v_mfma_f32_16x16x32_bf16 a[40:43], v[40:43], v[56:59], a[40:43]
    v_mfma_f32_16x16x32_bf16 a[44:47], v[44:47], v[56:59], a[44:47]
    v_mfma_f32_16x16x32_bf16 a[48:51], v[32:35], v[60:63], a[48:51]
    v_mfma_f32_16x16x32_bf16 a[52:55], v[36:39], v[60:63], a[52:55]
    v_mfma_f32_16x16x32_bf16 a[56:59], v[40:43], v[60:63], a[56:59]
    v_mfma_f32_16x16x32_bf16 a[60:63], v[44:47], v[60:63], a[60:63]
    s_add_u32 s7, s49, 8192
    s_add_u32 s20, s48, 8192
    buffer_load_dwordx4 v[32:35], v6, s[8:11], s7 offen offset:0
    buffer_load_dwordx4 v[48:51], v6, s[8:11], s20 offen offset:0
    buffer_load_dwordx4 v[36:39], v6, s[8:11], s7 offen offset:1024
    buffer_load_dwordx4 v[52:55], v6, s[8:11], s20 offen offset:1024
    buffer_load_dwordx4 v[40:43], v6, s[8:11], s7 offen offset:2048
    buffer_load_dwordx4 v[56:59], v6, s[8:11], s20 offen offset:2048
    buffer_load_dwordx4 v[44:47], v6, s[8:11], s7 offen offset:3072
    buffer_load_dwordx4 v[60:63], v6, s[8:11], s20 offen offset:3072
    s_waitcnt vmcnt(32)
    v_mfma_f32_16x16x32_bf16 a[0:3], v[64:67], v[80:83], a[0:3]
    v_mfma_f32_16x16x32_bf16 a[4:7], v[68:71], v[80:83], a[4:7]
    v_mfma_f32_16x16x32_bf16 a[8:11], v[72:75], v[80:83], a[8:11]
    v_mfma_f32_16x16x32_bf16 a[12:15], v[76:79], v[80:83], a[12:15]
    v_mfma_f32_16x16x32_bf16 a[16:19], v[64:67], v[84:87], a[16:19]
    v_mfma_f32_16x16x32_bf16 a[20:23], v[68:71], v[84:87], a[20:23]
    v_mfma_f32_16x16x32_bf16 a[24:27], v[72:75], v[84:87], a[24:27]
    v_mfma_f32_16x16x32_bf16 a[28:31], v[76:79], v[84:87], a[28:31]
    v_mfma_f32_16x16x32_bf16 a[32:35], v[64:67], v[88:91], a[32:35]
    v_mfma_f32_16x16x32_bf16 a[36:39], v[68:71], v[88:91], a[36:39]
    v_mfma_f32_16x16x32_bf16 a[40:43], v[72:75], v[88:91], a[40:43]
    v_mfma_f32_16x16x32_bf16 a[44:47], v[76:79], v[88:91], a[44:47]
    v_mfma_f32_16x16x32_bf16 a[48:51], v[64:67], v[92:95], a[48:51]
    v_mfma_f32_16x16x32_bf16 a[52:55], v[68:71], v[92:95], a[52:55]
    v_mfma_f32_16x16x32_bf16 a[56:59], v[72:75], v[92:95], a[56:59]
    v_mfma_f32_16x16x32_bf16 a[60:63], v[76:79], v[92:95], a[60:63]
    s_add_u32 s7, s49, 12288
    s_add_u32 s20, s48, 12288
    buffer_load_dwordx4 v[64:67], v6, s[8:11], s7 offen offset:0
    buffer_load_dwordx4 v[80:83], v6, s[8:11], s20 offen offset:0
    buffer_load_dwordx4 v[68:71], v6, s[8:11], s7 offen offset:1024
    buffer_load_dwordx4 v[84:87], v6, s[8:11], s20 offen offset:1024
    buffer_load_dwordx4 v[72:75], v6, s[8:11], s7 offen offset:2048
    buffer_load_dwordx4 v[88:91], v6, s[8:11], s20 offen offset:2048
    buffer_load_dwordx4 v[76:79], v6, s[8:11], s7 offen offset:3072
    buffer_load_dwordx4 v[92:95], v6, s[8:11], s20 offen offset:3072
    s_waitcnt vmcnt(32)
    v_mfma_f32_16x16x32_bf16 a[0:3], v[96:99], v[112:115], a[0:3]
    v_mfma_f32_16x16x32_bf16 a[4:7], v[100:103], v[112:115], a[4:7]
    v_mfma_f32_16x16x32_bf16 a[8:11], v[104:107], v[112:115], a[8:11]
    v_mfma_f32_16x16x32_bf16 a[12:15], v[108:111], v[112:115], a[12:15]
    v_mfma_f32_16x16x32_bf16 a[16:19], v[96:99], v[116:119], a[16:19]
    v_mfma_f32_16x16x32_bf16 a[20:23], v[100:103], v[116:119], a[20:23]
    v_mfma_f32_16x16x32_bf16 a[24:27], v[104:107], v[116:119], a[24:27]
    v_mfma_f32_16x16x32_bf16 a[28:31], v[108:111], v[116:119], a[28:31]
    v_mfma_f32_16x16x32_bf16 a[32:35], v[96:99], v[120:123], a[32:35]
    v_mfma_f32_16x16x32_bf16 a[36:39], v[100:103], v[120:123], a[36:39]
    v_mfma_f32_16x16x32_bf16 a[40:43], v[104:107], v[120:123], a[40:43]
    v_mfma_f32_16x16x32_bf16 a[44:47], v[108:111], v[120:123], a[44:47]
    v_mfma_f32_16x16x32_bf16 a[48:51], v[96:99], v[124:127], a[48:51]
    v_mfma_f32_16x16x32_bf16 a[52:55], v[100:103], v[124:127], a[52:55]
    v_mfma_f32_16x16x32_bf16 a[56:59], v[104:107], v[124:127], a[56:59]
    v_mfma_f32_16x16x32_bf16 a[60:63], v[108:111], v[124:127], a[60:63]
    s_add_u32 s7, s49, 16384
    s_add_u32 s20, s48, 16384
    buffer_load_dwordx4 v[96:99], v6, s[8:11], s7 offen offset:0
    buffer_load_dwordx4 v[112:115], v6, s[8:11], s20 offen offset:0
    buffer_load_dwordx4 v[100:103], v6, s[8:11], s7 offen offset:1024
    buffer_load_dwordx4 v[116:119], v6, s[8:11], s20 offen offset:1024
    buffer_load_dwordx4 v[104:107], v6, s[8:11], s7 offen offset:2048
    buffer_load_dwordx4 v[120:123], v6, s[8:11], s20 offen offset:2048
    buffer_load_dwordx4 v[108:111], v6, s[8:11], s7 offen offset:3072
    buffer_load_dwordx4 v[124:127], v6, s[8:11], s20 offen offset:3072
    s_waitcnt vmcnt(32)
    v_mfma_f32_16x16x32_bf16 a[64:67], v[128:131], v[144:147], 0
    v_mfma_f32_16x16x32_bf16 a[68:71], v[132:135], v[144:147], 0
    v_mfma_f32_16x16x32_bf16 a[72:75], v[136:139], v[144:147], 0
    v_mfma_f32_16x16x32_bf16 a[76:79], v[140:143], v[144:147], 0
    v_mfma_f32_16x16x32_bf16 a[80:83], v[128:131], v[148:151], 0
    v_mfma_f32_16x16x32_bf16 a[84:87], v[132:135], v[148:151], 0
    v_mfma_f32_16x16x32_bf16 a[88:91], v[136:139], v[148:151], 0
    v_mfma_f32_16x16x32_bf16 a[92:95], v[140:143], v[148:151], 0
    v_mfma_f32_16x16x32_bf16 a[96:99], v[128:131], v[152:155], 0
    v_mfma_f32_16x16x32_bf16 a[100:103], v[132:135], v[152:155], 0
    v_mfma_f32_16x16x32_bf16 a[104:107], v[136:139], v[152:155], 0
    v_mfma_f32_16x16x32_bf16 a[108:111], v[140:143], v[152:155], 0
    v_mfma_f32_16x16x32_bf16 a[112:115], v[128:131], v[156:159], 0
    v_mfma_f32_16x16x32_bf16 a[116:119], v[132:135], v[156:159], 0
    v_mfma_f32_16x16x32_bf16 a[120:123], v[136:139], v[156:159], 0
    v_mfma_f32_16x16x32_bf16 a[124:127], v[140:143], v[156:159], 0
    s_add_u32 s7, s49, 20480
    s_add_u32 s20, s48, 20480
    buffer_load_dwordx4 v[128:131], v6, s[8:11], s7 offen offset:0
    buffer_load_dwordx4 v[144:147], v6, s[8:11], s20 offen offset:0
    buffer_load_dwordx4 v[132:135], v6, s[8:11], s7 offen offset:1024
    buffer_load_dwordx4 v[148:151], v6, s[8:11], s20 offen offset:1024
    buffer_load_dwordx4 v[136:139], v6, s[8:11], s7 offen offset:2048
    buffer_load_dwordx4 v[152:155], v6, s[8:11], s20 offen offset:2048
    buffer_load_dwordx4 v[140:143], v6, s[8:11], s7 offen offset:3072
    buffer_load_dwordx4 v[156:159], v6, s[8:11], s20 offen offset:3072
    s_waitcnt vmcnt(32)
    v_mfma_f32_16x16x32_bf16 a[64:67], v[160:163], v[176:179], a[64:67]
    v_mfma_f32_16x16x32_bf16 a[68:71], v[164:167], v[176:179], a[68:71]
    v_mfma_f32_16x16x32_bf16 a[72:75], v[168:171], v[176:179], a[72:75]
    v_mfma_f32_16x16x32_bf16 a[76:79], v[172:175], v[176:179], a[76:79]
    v_mfma_f32_16x16x32_bf16 a[80:83], v[160:163], v[180:183], a[80:83]
    v_mfma_f32_16x16x32_bf16 a[84:87], v[164:167], v[180:183], a[84:87]
    v_mfma_f32_16x16x32_bf16 a[88:91], v[168:171], v[180:183], a[88:91]
    v_mfma_f32_16x16x32_bf16 a[92:95], v[172:175], v[180:183], a[92:95]
    v_mfma_f32_16x16x32_bf16 a[96:99], v[160:163], v[184:187], a[96:99]
    v_mfma_f32_16x16x32_bf16 a[100:103], v[164:167], v[184:187], a[100:103]
    v_mfma_f32_16x16x32_bf16 a[104:107], v[168:171], v[184:187], a[104:107]
    v_mfma_f32_16x16x32_bf16 a[108:111], v[172:175], v[184:187], a[108:111]
    v_mfma_f32_16x16x32_bf16 a[112:115], v[160:163], v[188:191], a[112:115]
    v_mfma_f32_16x16x32_bf16 a[116:119], v[164:167], v[188:191], a[116:119]
    v_mfma_f32_16x16x32_bf16 a[120:123], v[168:171], v[188:191], a[120:123]
    v_mfma_f32_16x16x32_bf16 a[124:127], v[172:175], v[188:191], a[124:127]
    s_add_u32 s7, s49, 24576
    s_add_u32 s20, s48, 24576
    buffer_load_dwordx4 v[160:163], v6, s[8:11], s7 offen offset:0
    buffer_load_dwordx4 v[176:179], v6, s[8:11], s20 offen offset:0
    buffer_load_dwordx4 v[164:167], v6, s[8:11], s7 offen offset:1024
    buffer_load_dwordx4 v[180:183], v6, s[8:11], s20 offen offset:1024
    buffer_load_dwordx4 v[168:171], v6, s[8:11], s7 offen offset:2048
    buffer_load_dwordx4 v[184:187], v6, s[8:11], s20 offen offset:2048
    buffer_load_dwordx4 v[172:175], v6, s[8:11], s7 offen offset:3072
    buffer_load_dwordx4 v[188:191], v6, s[8:11], s20 offen offset:3072
    ds_write_b128 v9, a[0:3] offset:0
    ds_write_b128 v9, a[4:7] offset:1024
    ds_write_b128 v9, a[8:11] offset:2048
    ds_write_b128 v9, a[12:15] offset:3072
    ds_write_b128 v9, a[16:19] offset:16384
    ds_write_b128 v9, a[20:23] offset:17408
    ds_write_b128 v9, a[24:27] offset:18432
    ds_write_b128 v9, a[28:31] offset:19456
    ds_write_b128 v9, a[32:35] offset:32768
    ds_write_b128 v9, a[36:39] offset:33792
    ds_write_b128 v9, a[40:43] offset:34816
    ds_write_b128 v9, a[44:47] offset:35840
    ds_write_b128 v9, a[48:51] offset:49152
    ds_write_b128 v9, a[52:55] offset:50176
    ds_write_b128 v9, a[56:59] offset:51200
    ds_write_b128 v9, a[60:63] offset:52224
    s_waitcnt vmcnt(32)
    v_mfma_f32_16x16x32_bf16 a[64:67], v[32:35], v[48:51], a[64:67]
    v_mfma_f32_16x16x32_bf16 a[68:71], v[36:39], v[48:51], a[68:71]
    v_mfma_f32_16x16x32_bf16 a[72:75], v[40:43], v[48:51], a[72:75]
    v_mfma_f32_16x16x32_bf16 a[76:79], v[44:47], v[48:51], a[76:79]
    v_mfma_f32_16x16x32_bf16 a[80:83], v[32:35], v[52:55], a[80:83]
    v_mfma_f32_16x16x32_bf16 a[84:87], v[36:39], v[52:55], a[84:87]
    v_mfma_f32_16x16x32_bf16 a[88:91], v[40:43], v[52:55], a[88:91]
    v_mfma_f32_16x16x32_bf16 a[92:95], v[44:47], v[52:55], a[92:95]
    v_mfma_f32_16x16x32_bf16 a[96:99], v[32:35], v[56:59], a[96:99]
    v_mfma_f32_16x16x32_bf16 a[100:103], v[36:39], v[56:59], a[100:103]
    v_mfma_f32_16x16x32_bf16 a[104:107], v[40:43], v[56:59], a[104:107]
    v_mfma_f32_16x16x32_bf16 a[108:111], v[44:47], v[56:59], a[108:111]
    v_mfma_f32_16x16x32_bf16 a[112:115], v[32:35], v[60:63], a[112:115]
    v_mfma_f32_16x16x32_bf16 a[116:119], v[36:39], v[60:63], a[116:119]
    v_mfma_f32_16x16x32_bf16 a[120:123], v[40:43], v[60:63], a[120:123]
    v_mfma_f32_16x16x32_bf16 a[124:127], v[44:47], v[60:63], a[124:127]
    s_add_u32 s7, s49, 28672
    s_add_u32 s20, s48, 28672
    buffer_load_dwordx4 v[32:35], v6, s[8:11], s7 offen offset:0
    buffer_load_dwordx4 v[48:51], v6, s[8:11], s20 offen offset:0
    buffer_load_dwordx4 v[36:39], v6, s[8:11], s7 offen offset:1024
    buffer_load_dwordx4 v[52:55], v6, s[8:11], s20 offen offset:1024
    buffer_load_dwordx4 v[40:43], v6, s[8:11], s7 offen offset:2048
    buffer_load_dwordx4 v[56:59], v6, s[8:11], s20 offen offset:2048
    buffer_load_dwordx4 v[44:47], v6, s[8:11], s7 offen offset:3072
    buffer_load_dwordx4 v[60:63], v6, s[8:11], s20 offen offset:3072
    s_waitcnt vmcnt(32)
    v_mfma_f32_16x16x32_bf16 a[64:67], v[64:67], v[80:83], a[64:67]
    v_mfma_f32_16x16x32_bf16 a[68:71], v[68:71], v[80:83], a[68:71]
    v_mfma_f32_16x16x32_bf16 a[72:75], v[72:75], v[80:83], a[72:75]
    v_mfma_f32_16x16x32_bf16 a[76:79], v[76:79], v[80:83], a[76:79]
    v_mfma_f32_16x16x32_bf16 a[80:83], v[64:67], v[84:87], a[80:83]
    v_mfma_f32_16x16x32_bf16 a[84:87], v[68:71], v[84:87], a[84:87]
    v_mfma_f32_16x16x32_bf16 a[88:91], v[72:75], v[84:87], a[88:91]
    v_mfma_f32_16x16x32_bf16 a[92:95], v[76:79], v[84:87], a[92:95]
    v_mfma_f32_16x16x32_bf16 a[96:99], v[64:67], v[88:91], a[96:99]
    v_mfma_f32_16x16x32_bf16 a[100:103], v[68:71], v[88:91], a[100:103]
    v_mfma_f32_16x16x32_bf16 a[104:107], v[72:75], v[88:91], a[104:107]
    v_mfma_f32_16x16x32_bf16 a[108:111], v[76:79], v[88:91], a[108:111]
    v_mfma_f32_16x16x32_bf16 a[112:115], v[64:67], v[92:95], a[112:115]
    v_mfma_f32_16x16x32_bf16 a[116:119], v[68:71], v[92:95], a[116:119]
    v_mfma_f32_16x16x32_bf16 a[120:123], v[72:75], v[92:95], a[120:123]
    v_mfma_f32_16x16x32_bf16 a[124:127], v[76:79], v[92:95], a[124:127]
    s_add_u32 s7, s49, 32768
    s_add_u32 s20, s48, 32768
    buffer_load_dwordx4 v[64:67], v6, s[8:11], s7 offen offset:0
    buffer_load_dwordx4 v[80:83], v6, s[8:11], s20 offen offset:0
    buffer_load_dwordx4 v[68:71], v6, s[8:11], s7 offen offset:1024
    buffer_load_dwordx4 v[84:87], v6, s[8:11], s20 offen offset:1024
    buffer_load_dwordx4 v[72:75], v6, s[8:11], s7 offen offset:2048
    buffer_load_dwordx4 v[88:91], v6, s[8:11], s20 offen offset:2048
    buffer_load_dwordx4 v[76:79], v6, s[8:11], s7 offen offset:3072
    buffer_load_dwordx4 v[92:95], v6, s[8:11], s20 offen offset:3072
    v_lshlrev_b32 v208, 16, v224
    v_and_b32 v209, 0xffff0000, v224
    v_sub_f32 v244, v208, v240
    v_sub_f32 v245, v209, v240
    v_cvt_pk_bf16_f32 v246, v244, v245
    v_lshlrev_b32 v244, 16, v246
    v_and_b32 v245, 0xffff0000, v246
    v_mul_f32 v244, v244, v241
    v_mul_f32 v245, v245, v241
    v_cvt_pk_bf16_f32 v246, v244, v245
    v_lshlrev_b32 v244, 16, v246
    v_and_b32 v245, 0xffff0000, v246
    v_lshlrev_b32 v247, 16, v232
    v_and_b32 v248, 0xffff0000, v232
    v_mul_f32 v244, v244, v247
    v_mul_f32 v245, v245, v248
    v_cvt_pk_bf16_f32 v246, v244, v245
    v_lshlrev_b32 v192, 16, v246
    v_and_b32 v193, 0xffff0000, v246
    v_lshlrev_b32 v210, 16, v225
    v_and_b32 v211, 0xffff0000, v225
    v_sub_f32 v244, v210, v240
    v_sub_f32 v245, v211, v240
    v_cvt_pk_bf16_f32 v246, v244, v245
    v_lshlrev_b32 v244, 16, v246
    v_and_b32 v245, 0xffff0000, v246
    v_mul_f32 v244, v244, v241
    v_mul_f32 v245, v245, v241
    v_cvt_pk_bf16_f32 v246, v244, v245
    v_lshlrev_b32 v244, 16, v246
    v_and_b32 v245, 0xffff0000, v246
    v_lshlrev_b32 v247, 16, v233
    v_and_b32 v248, 0xffff0000, v233
    v_mul_f32 v244, v244, v247
    v_mul_f32 v245, v245, v248
    v_cvt_pk_bf16_f32 v246, v244, v245
    v_lshlrev_b32 v194, 16, v246
    v_and_b32 v195, 0xffff0000, v246
    v_lshlrev_b32 v212, 16, v226
    v_and_b32 v213, 0xffff0000, v226
    v_sub_f32 v244, v212, v240
    v_sub_f32 v245, v213, v240
    v_cvt_pk_bf16_f32 v246, v244, v245
    v_lshlrev_b32 v244, 16, v246
    v_and_b32 v245, 0xffff0000, v246
    v_mul_f32 v244, v244, v241
    v_mul_f32 v245, v245, v241
    v_cvt_pk_bf16_f32 v246, v244, v245
    v_lshlrev_b32 v244, 16, v246
    v_and_b32 v245, 0xffff0000, v246
    v_lshlrev_b32 v247, 16, v234
    v_and_b32 v248, 0xffff0000, v234
    v_mul_f32 v244, v244, v247
    v_mul_f32 v245, v245, v248
    v_cvt_pk_bf16_f32 v246, v244, v245
    v_lshlrev_b32 v196, 16, v246
    v_and_b32 v197, 0xffff0000, v246
    v_lshlrev_b32 v214, 16, v227
    v_and_b32 v215, 0xffff0000, v227
    v_sub_f32 v244, v214, v240
    v_sub_f32 v245, v215, v240
    v_cvt_pk_bf16_f32 v246, v244, v245
    v_lshlrev_b32 v244, 16, v246
    v_and_b32 v245, 0xffff0000, v246
    v_mul_f32 v244, v244, v241
    v_mul_f32 v245, v245, v241
    v_cvt_pk_bf16_f32 v246, v244, v245
    v_lshlrev_b32 v244, 16, v246
    v_and_b32 v245, 0xffff0000, v246
    v_lshlrev_b32 v247, 16, v235
    v_and_b32 v248, 0xffff0000, v235
    v_mul_f32 v244, v244, v247
    v_mul_f32 v245, v245, v248
    v_cvt_pk_bf16_f32 v246, v244, v245
    v_lshlrev_b32 v198, 16, v246
    v_and_b32 v199, 0xffff0000, v246
    v_lshlrev_b32 v216, 16, v228
    v_and_b32 v217, 0xffff0000, v228
    v_sub_f32 v244, v216, v240
    v_sub_f32 v245, v217, v240
    v_cvt_pk_bf16_f32 v246, v244, v245
    v_lshlrev_b32 v244, 16, v246
    v_and_b32 v245, 0xffff0000, v246
    v_mul_f32 v244, v244, v241
    v_mul_f32 v245, v245, v241
    v_cvt_pk_bf16_f32 v246, v244, v245
    v_lshlrev_b32 v244, 16, v246
    v_and_b32 v245, 0xffff0000, v246
    v_lshlrev_b32 v247, 16, v236
    v_and_b32 v248, 0xffff0000, v236
    v_mul_f32 v244, v244, v247
    v_mul_f32 v245, v245, v248
    v_cvt_pk_bf16_f32 v246, v244, v245
    v_lshlrev_b32 v200, 16, v246
    v_and_b32 v201, 0xffff0000, v246
    v_lshlrev_b32 v218, 16, v229
    v_and_b32 v219, 0xffff0000, v229
    v_sub_f32 v244, v218, v240
    v_sub_f32 v245, v219, v240
    v_cvt_pk_bf16_f32 v246, v244, v245
    v_lshlrev_b32 v244, 16, v246
    v_and_b32 v245, 0xffff0000, v246
    v_mul_f32 v244, v244, v241
    v_mul_f32 v245, v245, v241
    v_cvt_pk_bf16_f32 v246, v244, v245
    v_lshlrev_b32 v244, 16, v246
    v_and_b32 v245, 0xffff0000, v246
    v_lshlrev_b32 v247, 16, v237
    v_and_b32 v248, 0xffff0000, v237
    v_mul_f32 v244, v244, v247
    v_mul_f32 v245, v245, v248
    v_cvt_pk_bf16_f32 v246, v244, v245
    v_lshlrev_b32 v202, 16, v246
    v_and_b32 v203, 0xffff0000, v246
    v_lshlrev_b32 v220, 16, v230
    v_and_b32 v221, 0xffff0000, v230
    v_sub_f32 v244, v220, v240
    v_sub_f32 v245, v221, v240
    v_cvt_pk_bf16_f32 v246, v244, v245
    v_lshlrev_b32 v244, 16, v246
    v_and_b32 v245, 0xffff0000, v246
    v_mul_f32 v244, v244, v241
    v_mul_f32 v245, v245, v241
    v_cvt_pk_bf16_f32 v246, v244, v245
    v_lshlrev_b32 v244, 16, v246
    v_and_b32 v245, 0xffff0000, v246
    v_lshlrev_b32 v247, 16, v238
    v_and_b32 v248, 0xffff0000, v238
    v_mul_f32 v244, v244, v247
    v_mul_f32 v245, v245, v248
    v_cvt_pk_bf16_f32 v246, v244, v245
    v_lshlrev_b32 v204, 16, v246
    v_and_b32 v205, 0xffff0000, v246
    v_lshlrev_b32 v222, 16, v231
    v_and_b32 v223, 0xffff0000, v231
    v_sub_f32 v244, v222, v240
    v_sub_f32 v245, v223, v240
    v_cvt_pk_bf16_f32 v246, v244, v245
    v_lshlrev_b32 v244, 16, v246
    v_and_b32 v245, 0xffff0000, v246
    v_mul_f32 v244, v244, v241
    v_mul_f32 v245, v245, v241
    v_cvt_pk_bf16_f32 v246, v244, v245
    v_lshlrev_b32 v244, 16, v246
    v_and_b32 v245, 0xffff0000, v246
    v_lshlrev_b32 v247, 16, v239
    v_and_b32 v248, 0xffff0000, v239
    v_mul_f32 v244, v244, v247
    v_mul_f32 v245, v245, v248
    v_cvt_pk_bf16_f32 v246, v244, v245
    v_lshlrev_b32 v206, 16, v246
    v_and_b32 v207, 0xffff0000, v246
    s_waitcnt vmcnt(32)
    v_mfma_f32_16x16x32_bf16 a[64:67], v[96:99], v[112:115], a[64:67]
    v_mfma_f32_16x16x32_bf16 a[68:71], v[100:103], v[112:115], a[68:71]
    v_mfma_f32_16x16x32_bf16 a[72:75], v[104:107], v[112:115], a[72:75]
    v_mfma_f32_16x16x32_bf16 a[76:79], v[108:111], v[112:115], a[76:79]
    v_mfma_f32_16x16x32_bf16 a[80:83], v[96:99], v[116:119], a[80:83]
    v_mfma_f32_16x16x32_bf16 a[84:87], v[100:103], v[116:119], a[84:87]
    v_mfma_f32_16x16x32_bf16 a[88:91], v[104:107], v[116:119], a[88:91]
    v_mfma_f32_16x16x32_bf16 a[92:95], v[108:111], v[116:119], a[92:95]
    v_mfma_f32_16x16x32_bf16 a[96:99], v[96:99], v[120:123], a[96:99]
    v_mfma_f32_16x16x32_bf16 a[100:103], v[100:103], v[120:123], a[100:103]
    v_mfma_f32_16x16x32_bf16 a[104:107], v[104:107], v[120:123], a[104:107]
    v_mfma_f32_16x16x32_bf16 a[108:111], v[108:111], v[120:123], a[108:111]
    v_mfma_f32_16x16x32_bf16 a[112:115], v[96:99], v[124:127], a[112:115]
    v_mfma_f32_16x16x32_bf16 a[116:119], v[100:103], v[124:127], a[116:119]
    v_mfma_f32_16x16x32_bf16 a[120:123], v[104:107], v[124:127], a[120:123]
    v_mfma_f32_16x16x32_bf16 a[124:127], v[108:111], v[124:127], a[124:127]
    s_add_u32 s7, s49, 36864
    s_add_u32 s20, s48, 36864
    buffer_load_dwordx4 v[96:99], v6, s[8:11], s7 offen offset:0
    buffer_load_dwordx4 v[112:115], v6, s[8:11], s20 offen offset:0
    buffer_load_dwordx4 v[100:103], v6, s[8:11], s7 offen offset:1024
    buffer_load_dwordx4 v[116:119], v6, s[8:11], s20 offen offset:1024
    buffer_load_dwordx4 v[104:107], v6, s[8:11], s7 offen offset:2048
    buffer_load_dwordx4 v[120:123], v6, s[8:11], s20 offen offset:2048
    buffer_load_dwordx4 v[108:111], v6, s[8:11], s7 offen offset:3072
    buffer_load_dwordx4 v[124:127], v6, s[8:11], s20 offen offset:3072
    s_waitcnt vmcnt(32)
    v_mfma_f32_16x16x32_bf16 a[64:67], v[128:131], v[144:147], a[64:67]
    v_mfma_f32_16x16x32_bf16 a[68:71], v[132:135], v[144:147], a[68:71]
    v_mfma_f32_16x16x32_bf16 a[72:75], v[136:139], v[144:147], a[72:75]
    v_mfma_f32_16x16x32_bf16 a[76:79], v[140:143], v[144:147], a[76:79]
    v_mfma_f32_16x16x32_bf16 a[80:83], v[128:131], v[148:151], a[80:83]
    v_mfma_f32_16x16x32_bf16 a[84:87], v[132:135], v[148:151], a[84:87]
    v_mfma_f32_16x16x32_bf16 a[88:91], v[136:139], v[148:151], a[88:91]
    v_mfma_f32_16x16x32_bf16 a[92:95], v[140:143], v[148:151], a[92:95]
    v_mfma_f32_16x16x32_bf16 a[96:99], v[128:131], v[152:155], a[96:99]
    v_mfma_f32_16x16x32_bf16 a[100:103], v[132:135], v[152:155], a[100:103]
    v_mfma_f32_16x16x32_bf16 a[104:107], v[136:139], v[152:155], a[104:107]
    v_mfma_f32_16x16x32_bf16 a[108:111], v[140:143], v[152:155], a[108:111]
    v_mfma_f32_16x16x32_bf16 a[112:115], v[128:131], v[156:159], a[112:115]
    v_mfma_f32_16x16x32_bf16 a[116:119], v[132:135], v[156:159], a[116:119]
    v_mfma_f32_16x16x32_bf16 a[120:123], v[136:139], v[156:159], a[120:123]
    v_mfma_f32_16x16x32_bf16 a[124:127], v[140:143], v[156:159], a[124:127]
    s_add_u32 s7, s49, 40960
    s_add_u32 s20, s48, 40960
    buffer_load_dwordx4 v[128:131], v6, s[8:11], s7 offen offset:0
    buffer_load_dwordx4 v[144:147], v6, s[8:11], s20 offen offset:0
    buffer_load_dwordx4 v[132:135], v6, s[8:11], s7 offen offset:1024
    buffer_load_dwordx4 v[148:151], v6, s[8:11], s20 offen offset:1024
    buffer_load_dwordx4 v[136:139], v6, s[8:11], s7 offen offset:2048
    buffer_load_dwordx4 v[152:155], v6, s[8:11], s20 offen offset:2048
    buffer_load_dwordx4 v[140:143], v6, s[8:11], s7 offen offset:3072
    buffer_load_dwordx4 v[156:159], v6, s[8:11], s20 offen offset:3072
    s_waitcnt vmcnt(32)
    v_mfma_f32_16x16x32_bf16 a[64:67], v[160:163], v[176:179], a[64:67]
    v_mfma_f32_16x16x32_bf16 a[68:71], v[164:167], v[176:179], a[68:71]
    v_mfma_f32_16x16x32_bf16 a[72:75], v[168:171], v[176:179], a[72:75]
    v_mfma_f32_16x16x32_bf16 a[76:79], v[172:175], v[176:179], a[76:79]
    v_mfma_f32_16x16x32_bf16 a[80:83], v[160:163], v[180:183], a[80:83]
    v_mfma_f32_16x16x32_bf16 a[84:87], v[164:167], v[180:183], a[84:87]
    v_mfma_f32_16x16x32_bf16 a[88:91], v[168:171], v[180:183], a[88:91]
    v_mfma_f32_16x16x32_bf16 a[92:95], v[172:175], v[180:183], a[92:95]
    v_mfma_f32_16x16x32_bf16 a[96:99], v[160:163], v[184:187], a[96:99]
    v_mfma_f32_16x16x32_bf16 a[100:103], v[164:167], v[184:187], a[100:103]
    v_mfma_f32_16x16x32_bf16 a[104:107], v[168:171], v[184:187], a[104:107]
    v_mfma_f32_16x16x32_bf16 a[108:111], v[172:175], v[184:187], a[108:111]
    v_mfma_f32_16x16x32_bf16 a[112:115], v[160:163], v[188:191], a[112:115]
    v_mfma_f32_16x16x32_bf16 a[116:119], v[164:167], v[188:191], a[116:119]
    v_mfma_f32_16x16x32_bf16 a[120:123], v[168:171], v[188:191], a[120:123]
    v_mfma_f32_16x16x32_bf16 a[124:127], v[172:175], v[188:191], a[124:127]
    s_add_u32 s7, s49, 45056
    s_add_u32 s20, s48, 45056
    buffer_load_dwordx4 v[160:163], v6, s[8:11], s7 offen offset:0
    buffer_load_dwordx4 v[176:179], v6, s[8:11], s20 offen offset:0
    buffer_load_dwordx4 v[164:167], v6, s[8:11], s7 offen offset:1024
    buffer_load_dwordx4 v[180:183], v6, s[8:11], s20 offen offset:1024
    buffer_load_dwordx4 v[168:171], v6, s[8:11], s7 offen offset:2048
    buffer_load_dwordx4 v[184:187], v6, s[8:11], s20 offen offset:2048
    buffer_load_dwordx4 v[172:175], v6, s[8:11], s7 offen offset:3072
    buffer_load_dwordx4 v[188:191], v6, s[8:11], s20 offen offset:3072
    s_waitcnt vmcnt(32)
    v_mfma_f32_16x16x32_bf16 a[64:67], v[32:35], v[48:51], a[64:67]
    v_mfma_f32_16x16x32_bf16 a[68:71], v[36:39], v[48:51], a[68:71]
    v_mfma_f32_16x16x32_bf16 a[72:75], v[40:43], v[48:51], a[72:75]
    v_mfma_f32_16x16x32_bf16 a[76:79], v[44:47], v[48:51], a[76:79]
    v_mfma_f32_16x16x32_bf16 a[80:83], v[32:35], v[52:55], a[80:83]
    v_mfma_f32_16x16x32_bf16 a[84:87], v[36:39], v[52:55], a[84:87]
    v_mfma_f32_16x16x32_bf16 a[88:91], v[40:43], v[52:55], a[88:91]
    v_mfma_f32_16x16x32_bf16 a[92:95], v[44:47], v[52:55], a[92:95]
    v_mfma_f32_16x16x32_bf16 a[96:99], v[32:35], v[56:59], a[96:99]
    v_mfma_f32_16x16x32_bf16 a[100:103], v[36:39], v[56:59], a[100:103]
    v_mfma_f32_16x16x32_bf16 a[104:107], v[40:43], v[56:59], a[104:107]
    v_mfma_f32_16x16x32_bf16 a[108:111], v[44:47], v[56:59], a[108:111]
    v_mfma_f32_16x16x32_bf16 a[112:115], v[32:35], v[60:63], a[112:115]
    v_mfma_f32_16x16x32_bf16 a[116:119], v[36:39], v[60:63], a[116:119]
    v_mfma_f32_16x16x32_bf16 a[120:123], v[40:43], v[60:63], a[120:123]
    v_mfma_f32_16x16x32_bf16 a[124:127], v[44:47], v[60:63], a[124:127]
    s_add_u32 s7, s49, 49152
    s_add_u32 s20, s48, 49152
    buffer_load_dwordx4 v[32:35], v6, s[8:11], s7 offen offset:0
    buffer_load_dwordx4 v[48:51], v6, s[8:11], s20 offen offset:0
    buffer_load_dwordx4 v[36:39], v6, s[8:11], s7 offen offset:1024
    buffer_load_dwordx4 v[52:55], v6, s[8:11], s20 offen offset:1024
    buffer_load_dwordx4 v[40:43], v6, s[8:11], s7 offen offset:2048
    buffer_load_dwordx4 v[56:59], v6, s[8:11], s20 offen offset:2048
    buffer_load_dwordx4 v[44:47], v6, s[8:11], s7 offen offset:3072
    buffer_load_dwordx4 v[60:63], v6, s[8:11], s20 offen offset:3072
    s_waitcnt vmcnt(32)
    v_mfma_f32_16x16x32_bf16 a[64:67], v[64:67], v[80:83], a[64:67]
    v_mfma_f32_16x16x32_bf16 a[68:71], v[68:71], v[80:83], a[68:71]
    v_mfma_f32_16x16x32_bf16 a[72:75], v[72:75], v[80:83], a[72:75]
    v_mfma_f32_16x16x32_bf16 a[76:79], v[76:79], v[80:83], a[76:79]
    v_mfma_f32_16x16x32_bf16 a[80:83], v[64:67], v[84:87], a[80:83]
    v_mfma_f32_16x16x32_bf16 a[84:87], v[68:71], v[84:87], a[84:87]
    v_mfma_f32_16x16x32_bf16 a[88:91], v[72:75], v[84:87], a[88:91]
    v_mfma_f32_16x16x32_bf16 a[92:95], v[76:79], v[84:87], a[92:95]
    v_mfma_f32_16x16x32_bf16 a[96:99], v[64:67], v[88:91], a[96:99]
    v_mfma_f32_16x16x32_bf16 a[100:103], v[68:71], v[88:91], a[100:103]
    v_mfma_f32_16x16x32_bf16 a[104:107], v[72:75], v[88:91], a[104:107]
    v_mfma_f32_16x16x32_bf16 a[108:111], v[76:79], v[88:91], a[108:111]
    v_mfma_f32_16x16x32_bf16 a[112:115], v[64:67], v[92:95], a[112:115]
    v_mfma_f32_16x16x32_bf16 a[116:119], v[68:71], v[92:95], a[116:119]
    v_mfma_f32_16x16x32_bf16 a[120:123], v[72:75], v[92:95], a[120:123]
    v_mfma_f32_16x16x32_bf16 a[124:127], v[76:79], v[92:95], a[124:127]
    s_add_u32 s7, s49, 53248
    s_add_u32 s20, s48, 53248
    buffer_load_dwordx4 v[64:67], v6, s[8:11], s7 offen offset:0
    buffer_load_dwordx4 v[80:83], v6, s[8:11], s20 offen offset:0
    buffer_load_dwordx4 v[68:71], v6, s[8:11], s7 offen offset:1024
    buffer_load_dwordx4 v[84:87], v6, s[8:11], s20 offen offset:1024
    buffer_load_dwordx4 v[72:75], v6, s[8:11], s7 offen offset:2048
    buffer_load_dwordx4 v[88:91], v6, s[8:11], s20 offen offset:2048
    buffer_load_dwordx4 v[76:79], v6, s[8:11], s7 offen offset:3072
    buffer_load_dwordx4 v[92:95], v6, s[8:11], s20 offen offset:3072
    s_waitcnt vmcnt(32)
    v_mfma_f32_16x16x32_bf16 a[64:67], v[96:99], v[112:115], a[64:67]
    v_mfma_f32_16x16x32_bf16 a[68:71], v[100:103], v[112:115], a[68:71]
    v_mfma_f32_16x16x32_bf16 a[72:75], v[104:107], v[112:115], a[72:75]
    v_mfma_f32_16x16x32_bf16 a[76:79], v[108:111], v[112:115], a[76:79]
    v_mfma_f32_16x16x32_bf16 a[80:83], v[96:99], v[116:119], a[80:83]
    v_mfma_f32_16x16x32_bf16 a[84:87], v[100:103], v[116:119], a[84:87]
    v_mfma_f32_16x16x32_bf16 a[88:91], v[104:107], v[116:119], a[88:91]
    v_mfma_f32_16x16x32_bf16 a[92:95], v[108:111], v[116:119], a[92:95]
    v_mfma_f32_16x16x32_bf16 a[96:99], v[96:99], v[120:123], a[96:99]
    v_mfma_f32_16x16x32_bf16 a[100:103], v[100:103], v[120:123], a[100:103]
    v_mfma_f32_16x16x32_bf16 a[104:107], v[104:107], v[120:123], a[104:107]
    v_mfma_f32_16x16x32_bf16 a[108:111], v[108:111], v[120:123], a[108:111]
    v_mfma_f32_16x16x32_bf16 a[112:115], v[96:99], v[124:127], a[112:115]
    v_mfma_f32_16x16x32_bf16 a[116:119], v[100:103], v[124:127], a[116:119]
    v_mfma_f32_16x16x32_bf16 a[120:123], v[104:107], v[124:127], a[120:123]
    v_mfma_f32_16x16x32_bf16 a[124:127], v[108:111], v[124:127], a[124:127]
    s_waitcnt vmcnt(24)
    v_mfma_f32_16x16x32_bf16 a[64:67], v[128:131], v[144:147], a[64:67]
    v_mfma_f32_16x16x32_bf16 a[68:71], v[132:135], v[144:147], a[68:71]
    v_mfma_f32_16x16x32_bf16 a[72:75], v[136:139], v[144:147], a[72:75]
    v_mfma_f32_16x16x32_bf16 a[76:79], v[140:143], v[144:147], a[76:79]
    v_mfma_f32_16x16x32_bf16 a[80:83], v[128:131], v[148:151], a[80:83]
    v_mfma_f32_16x16x32_bf16 a[84:87], v[132:135], v[148:151], a[84:87]
    v_mfma_f32_16x16x32_bf16 a[88:91], v[136:139], v[148:151], a[88:91]
    v_mfma_f32_16x16x32_bf16 a[92:95], v[140:143], v[148:151], a[92:95]
    v_mfma_f32_16x16x32_bf16 a[96:99], v[128:131], v[152:155], a[96:99]
    v_mfma_f32_16x16x32_bf16 a[100:103], v[132:135], v[152:155], a[100:103]
    v_mfma_f32_16x16x32_bf16 a[104:107], v[136:139], v[152:155], a[104:107]
    v_mfma_f32_16x16x32_bf16 a[108:111], v[140:143], v[152:155], a[108:111]
    v_mfma_f32_16x16x32_bf16 a[112:115], v[128:131], v[156:159], a[112:115]
    v_mfma_f32_16x16x32_bf16 a[116:119], v[132:135], v[156:159], a[116:119]
    v_mfma_f32_16x16x32_bf16 a[120:123], v[136:139], v[156:159], a[120:123]
    v_mfma_f32_16x16x32_bf16 a[124:127], v[140:143], v[156:159], a[124:127]
    s_waitcnt vmcnt(16)
    v_mfma_f32_16x16x32_bf16 a[64:67], v[160:163], v[176:179], a[64:67]
    v_mfma_f32_16x16x32_bf16 a[68:71], v[164:167], v[176:179], a[68:71]
    v_mfma_f32_16x16x32_bf16 a[72:75], v[168:171], v[176:179], a[72:75]
    v_mfma_f32_16x16x32_bf16 a[76:79], v[172:175], v[176:179], a[76:79]
    v_mfma_f32_16x16x32_bf16 a[80:83], v[160:163], v[180:183], a[80:83]
    v_mfma_f32_16x16x32_bf16 a[84:87], v[164:167], v[180:183], a[84:87]
    v_mfma_f32_16x16x32_bf16 a[88:91], v[168:171], v[180:183], a[88:91]
    v_mfma_f32_16x16x32_bf16 a[92:95], v[172:175], v[180:183], a[92:95]
    v_mfma_f32_16x16x32_bf16 a[96:99], v[160:163], v[184:187], a[96:99]
    v_mfma_f32_16x16x32_bf16 a[100:103], v[164:167], v[184:187], a[100:103]
    v_mfma_f32_16x16x32_bf16 a[104:107], v[168:171], v[184:187], a[104:107]
    v_mfma_f32_16x16x32_bf16 a[108:111], v[172:175], v[184:187], a[108:111]
    v_mfma_f32_16x16x32_bf16 a[112:115], v[160:163], v[188:191], a[112:115]
    v_mfma_f32_16x16x32_bf16 a[116:119], v[164:167], v[188:191], a[116:119]
    v_mfma_f32_16x16x32_bf16 a[120:123], v[168:171], v[188:191], a[120:123]
    v_mfma_f32_16x16x32_bf16 a[124:127], v[172:175], v[188:191], a[124:127]
    s_waitcnt vmcnt(8)
    v_mfma_f32_16x16x32_bf16 a[64:67], v[32:35], v[48:51], a[64:67]
    v_mfma_f32_16x16x32_bf16 a[68:71], v[36:39], v[48:51], a[68:71]
    v_mfma_f32_16x16x32_bf16 a[72:75], v[40:43], v[48:51], a[72:75]
    v_mfma_f32_16x16x32_bf16 a[76:79], v[44:47], v[48:51], a[76:79]
    v_mfma_f32_16x16x32_bf16 a[80:83], v[32:35], v[52:55], a[80:83]
    v_mfma_f32_16x16x32_bf16 a[84:87], v[36:39], v[52:55], a[84:87]
    v_mfma_f32_16x16x32_bf16 a[88:91], v[40:43], v[52:55], a[88:91]
    v_mfma_f32_16x16x32_bf16 a[92:95], v[44:47], v[52:55], a[92:95]
    v_mfma_f32_16x16x32_bf16 a[96:99], v[32:35], v[56:59], a[96:99]
    v_mfma_f32_16x16x32_bf16 a[100:103], v[36:39], v[56:59], a[100:103]
    v_mfma_f32_16x16x32_bf16 a[104:107], v[40:43], v[56:59], a[104:107]
    v_mfma_f32_16x16x32_bf16 a[108:111], v[44:47], v[56:59], a[108:111]
    v_mfma_f32_16x16x32_bf16 a[112:115], v[32:35], v[60:63], a[112:115]
    v_mfma_f32_16x16x32_bf16 a[116:119], v[36:39], v[60:63], a[116:119]
    v_mfma_f32_16x16x32_bf16 a[120:123], v[40:43], v[60:63], a[120:123]
    v_mfma_f32_16x16x32_bf16 a[124:127], v[44:47], v[60:63], a[124:127]
    s_waitcnt vmcnt(0)
    v_mfma_f32_16x16x32_bf16 a[64:67], v[64:67], v[80:83], a[64:67]
    v_mfma_f32_16x16x32_bf16 a[68:71], v[68:71], v[80:83], a[68:71]
    v_mfma_f32_16x16x32_bf16 a[72:75], v[72:75], v[80:83], a[72:75]
    v_mfma_f32_16x16x32_bf16 a[76:79], v[76:79], v[80:83], a[76:79]
    v_mfma_f32_16x16x32_bf16 a[80:83], v[64:67], v[84:87], a[80:83]
    v_mfma_f32_16x16x32_bf16 a[84:87], v[68:71], v[84:87], a[84:87]
    v_mfma_f32_16x16x32_bf16 a[88:91], v[72:75], v[84:87], a[88:91]
    v_mfma_f32_16x16x32_bf16 a[92:95], v[76:79], v[84:87], a[92:95]
    v_mfma_f32_16x16x32_bf16 a[96:99], v[64:67], v[88:91], a[96:99]
    v_mfma_f32_16x16x32_bf16 a[100:103], v[68:71], v[88:91], a[100:103]
    v_mfma_f32_16x16x32_bf16 a[104:107], v[72:75], v[88:91], a[104:107]
    v_mfma_f32_16x16x32_bf16 a[108:111], v[76:79], v[88:91], a[108:111]
    v_mfma_f32_16x16x32_bf16 a[112:115], v[64:67], v[92:95], a[112:115]
    v_mfma_f32_16x16x32_bf16 a[116:119], v[68:71], v[92:95], a[116:119]
    v_mfma_f32_16x16x32_bf16 a[120:123], v[72:75], v[92:95], a[120:123]
    v_mfma_f32_16x16x32_bf16 a[124:127], v[76:79], v[92:95], a[124:127]
    ds_write_b128 v10, a[64:67] offset:0
    ds_write_b128 v10, a[68:71] offset:1024
    ds_write_b128 v10, a[72:75] offset:2048
    ds_write_b128 v10, a[76:79] offset:3072
    ds_write_b128 v10, a[80:83] offset:16384
    ds_write_b128 v10, a[84:87] offset:17408
    ds_write_b128 v10, a[88:91] offset:18432
    ds_write_b128 v10, a[92:95] offset:19456
    ds_write_b128 v10, a[96:99] offset:32768
    ds_write_b128 v10, a[100:103] offset:33792
    ds_write_b128 v10, a[104:107] offset:34816
    ds_write_b128 v10, a[108:111] offset:35840
    ds_write_b128 v10, a[112:115] offset:49152
    ds_write_b128 v10, a[116:119] offset:50176
    ds_write_b128 v10, a[120:123] offset:51200
    ds_write_b128 v10, a[124:127] offset:52224
    v_lshlrev_b32 v11, 1, v11
    s_waitcnt lgkmcnt(0)
    s_barrier
    ds_read_b128 v[32:35], v16 offset:0
    ds_read_b128 v[36:39], v16 offset:1024
    ds_read_b128 v[40:43], v16 offset:2048
    ds_read_b128 v[44:47], v16 offset:3072
    ds_read_b128 v[48:51], v16 offset:4096
    ds_read_b128 v[52:55], v16 offset:5120
    ds_read_b128 v[56:59], v16 offset:6144
    ds_read_b128 v[60:63], v16 offset:7168
    ds_read_b128 v[64:67], v16 offset:8192
    ds_read_b128 v[68:71], v16 offset:9216
    ds_read_b128 v[72:75], v16 offset:10240
    ds_read_b128 v[76:79], v16 offset:11264
    ds_read_b128 v[80:83], v16 offset:12288
    ds_read_b128 v[84:87], v16 offset:13312
    ds_read_b128 v[88:91], v16 offset:14336
    ds_read_b128 v[92:95], v16 offset:15360
    ds_read_b128 v[128:131], v15 offset:0
    ds_read_b128 v[132:135], v15 offset:1024
    ds_read_b128 v[136:139], v15 offset:2048
    ds_read_b128 v[140:143], v15 offset:3072
    ds_read_b128 v[144:147], v15 offset:4096
    ds_read_b128 v[148:151], v15 offset:5120
    ds_read_b128 v[152:155], v15 offset:6144
    ds_read_b128 v[156:159], v15 offset:7168
    ds_read_b128 v[160:163], v15 offset:8192
    ds_read_b128 v[164:167], v15 offset:9216
    ds_read_b128 v[168:171], v15 offset:10240
    ds_read_b128 v[172:175], v15 offset:11264
    ds_read_b128 v[176:179], v15 offset:12288
    ds_read_b128 v[180:183], v15 offset:13312
    ds_read_b128 v[184:187], v15 offset:14336
    ds_read_b128 v[188:191], v15 offset:15360
    s_waitcnt lgkmcnt(15)
    v_add_f32 v32, v32, v48
    v_add_f32 v33, v33, v49
    v_add_f32 v34, v34, v50
    v_add_f32 v35, v35, v51
    v_add_f32 v36, v36, v52
    v_add_f32 v37, v37, v53
    v_add_f32 v38, v38, v54
    v_add_f32 v39, v39, v55
    v_add_f32 v40, v40, v56
    v_add_f32 v41, v41, v57
    v_add_f32 v42, v42, v58
    v_add_f32 v43, v43, v59
    v_add_f32 v44, v44, v60
    v_add_f32 v45, v45, v61
    v_add_f32 v46, v46, v62
    v_add_f32 v47, v47, v63
    v_add_f32 v64, v64, v80
    v_add_f32 v65, v65, v81
    v_add_f32 v66, v66, v82
    v_add_f32 v67, v67, v83
    v_add_f32 v68, v68, v84
    v_add_f32 v69, v69, v85
    v_add_f32 v70, v70, v86
    v_add_f32 v71, v71, v87
    v_add_f32 v72, v72, v88
    v_add_f32 v73, v73, v89
    v_add_f32 v74, v74, v90
    v_add_f32 v75, v75, v91
    v_add_f32 v76, v76, v92
    v_add_f32 v77, v77, v93
    v_add_f32 v78, v78, v94
    v_add_f32 v79, v79, v95
    v_add_f32 v32, v32, v64
    v_add_f32 v33, v33, v65
    v_add_f32 v34, v34, v66
    v_add_f32 v35, v35, v67
    v_add_f32 v36, v36, v68
    v_add_f32 v37, v37, v69
    v_add_f32 v38, v38, v70
    v_add_f32 v39, v39, v71
    v_add_f32 v40, v40, v72
    v_add_f32 v41, v41, v73
    v_add_f32 v42, v42, v74
    v_add_f32 v43, v43, v75
    v_add_f32 v44, v44, v76
    v_add_f32 v45, v45, v77
    v_add_f32 v46, v46, v78
    v_add_f32 v47, v47, v79
    v_cvt_pk_bf16_f32 v96, v32, v33
    v_cvt_pk_bf16_f32 v97, v34, v35
    v_cvt_pk_bf16_f32 v98, v36, v37
    v_cvt_pk_bf16_f32 v99, v38, v39
    v_cvt_pk_bf16_f32 v100, v40, v41
    v_cvt_pk_bf16_f32 v101, v42, v43
    v_cvt_pk_bf16_f32 v102, v44, v45
    v_cvt_pk_bf16_f32 v103, v46, v47
    v_lshlrev_b32 v32, 16, v96
    v_and_b32 v33, 0xffff0000, v96
    v_lshlrev_b32 v34, 16, v97
    v_and_b32 v35, 0xffff0000, v97
    v_lshlrev_b32 v36, 16, v98
    v_and_b32 v37, 0xffff0000, v98
    v_lshlrev_b32 v38, 16, v99
    v_and_b32 v39, 0xffff0000, v99
    v_lshlrev_b32 v40, 16, v100
    v_and_b32 v41, 0xffff0000, v100
    v_lshlrev_b32 v42, 16, v101
    v_and_b32 v43, 0xffff0000, v101
    v_lshlrev_b32 v44, 16, v102
    v_and_b32 v45, 0xffff0000, v102
    v_lshlrev_b32 v46, 16, v103
    v_and_b32 v47, 0xffff0000, v103
    v_mul_f32 v112, 0xbfb8aa3b, v32
    v_mul_f32 v113, 0xbfb8aa3b, v33
    v_mul_f32 v114, 0xbfb8aa3b, v34
    v_mul_f32 v115, 0xbfb8aa3b, v35
    v_mul_f32 v116, 0xbfb8aa3b, v36
    v_mul_f32 v117, 0xbfb8aa3b, v37
    v_mul_f32 v118, 0xbfb8aa3b, v38
    v_mul_f32 v119, 0xbfb8aa3b, v39
    v_mul_f32 v120, 0xbfb8aa3b, v40
    v_mul_f32 v121, 0xbfb8aa3b, v41
    v_mul_f32 v122, 0xbfb8aa3b, v42
    v_mul_f32 v123, 0xbfb8aa3b, v43
    v_mul_f32 v124, 0xbfb8aa3b, v44
    v_mul_f32 v125, 0xbfb8aa3b, v45
    v_mul_f32 v126, 0xbfb8aa3b, v46
    v_mul_f32 v127, 0xbfb8aa3b, v47
    v_exp_f32 v112, v112
    v_exp_f32 v113, v113
    v_exp_f32 v114, v114
    v_exp_f32 v115, v115
    v_exp_f32 v116, v116
    v_exp_f32 v117, v117
    v_exp_f32 v118, v118
    v_exp_f32 v119, v119
    v_exp_f32 v120, v120
    v_exp_f32 v121, v121
    v_exp_f32 v122, v122
    v_exp_f32 v123, v123
    v_exp_f32 v124, v124
    v_exp_f32 v125, v125
    v_exp_f32 v126, v126
    v_exp_f32 v127, v127
    v_add_f32 v112, 1.0, v112
    v_add_f32 v113, 1.0, v113
    v_add_f32 v114, 1.0, v114
    v_add_f32 v115, 1.0, v115
    v_add_f32 v116, 1.0, v116
    v_add_f32 v117, 1.0, v117
    v_add_f32 v118, 1.0, v118
    v_add_f32 v119, 1.0, v119
    v_add_f32 v120, 1.0, v120
    v_add_f32 v121, 1.0, v121
    v_add_f32 v122, 1.0, v122
    v_add_f32 v123, 1.0, v123
    v_add_f32 v124, 1.0, v124
    v_add_f32 v125, 1.0, v125
    v_add_f32 v126, 1.0, v126
    v_add_f32 v127, 1.0, v127
    v_rcp_f32 v112, v112
    v_rcp_f32 v113, v113
    v_rcp_f32 v114, v114
    v_rcp_f32 v115, v115
    v_rcp_f32 v116, v116
    v_rcp_f32 v117, v117
    v_rcp_f32 v118, v118
    v_rcp_f32 v119, v119
    v_rcp_f32 v120, v120
    v_rcp_f32 v121, v121
    v_rcp_f32 v122, v122
    v_rcp_f32 v123, v123
    v_rcp_f32 v124, v124
    v_rcp_f32 v125, v125
    v_rcp_f32 v126, v126
    v_rcp_f32 v127, v127
    v_mul_f32 v112, v32, v112
    v_mul_f32 v113, v33, v113
    v_mul_f32 v114, v34, v114
    v_mul_f32 v115, v35, v115
    v_mul_f32 v116, v36, v116
    v_mul_f32 v117, v37, v117
    v_mul_f32 v118, v38, v118
    v_mul_f32 v119, v39, v119
    v_mul_f32 v120, v40, v120
    v_mul_f32 v121, v41, v121
    v_mul_f32 v122, v42, v122
    v_mul_f32 v123, v43, v123
    v_mul_f32 v124, v44, v124
    v_mul_f32 v125, v45, v125
    v_mul_f32 v126, v46, v126
    v_mul_f32 v127, v47, v127
    v_cvt_pk_bf16_f32 v96, v112, v113
    v_cvt_pk_bf16_f32 v97, v114, v115
    v_cvt_pk_bf16_f32 v98, v116, v117
    v_cvt_pk_bf16_f32 v99, v118, v119
    v_cvt_pk_bf16_f32 v100, v120, v121
    v_cvt_pk_bf16_f32 v101, v122, v123
    v_cvt_pk_bf16_f32 v102, v124, v125
    v_cvt_pk_bf16_f32 v103, v126, v127
    v_lshlrev_b32 v32, 16, v96
    v_and_b32 v33, 0xffff0000, v96
    v_lshlrev_b32 v34, 16, v97
    v_and_b32 v35, 0xffff0000, v97
    v_lshlrev_b32 v36, 16, v98
    v_and_b32 v37, 0xffff0000, v98
    v_lshlrev_b32 v38, 16, v99
    v_and_b32 v39, 0xffff0000, v99
    v_lshlrev_b32 v40, 16, v100
    v_and_b32 v41, 0xffff0000, v100
    v_lshlrev_b32 v42, 16, v101
    v_and_b32 v43, 0xffff0000, v101
    v_lshlrev_b32 v44, 16, v102
    v_and_b32 v45, 0xffff0000, v102
    v_lshlrev_b32 v46, 16, v103
    v_and_b32 v47, 0xffff0000, v103
    s_waitcnt lgkmcnt(0)
    v_add_f32 v128, v128, v144
    v_add_f32 v129, v129, v145
    v_add_f32 v130, v130, v146
    v_add_f32 v131, v131, v147
    v_add_f32 v132, v132, v148
    v_add_f32 v133, v133, v149
    v_add_f32 v134, v134, v150
    v_add_f32 v135, v135, v151
    v_add_f32 v136, v136, v152
    v_add_f32 v137, v137, v153
    v_add_f32 v138, v138, v154
    v_add_f32 v139, v139, v155
    v_add_f32 v140, v140, v156
    v_add_f32 v141, v141, v157
    v_add_f32 v142, v142, v158
    v_add_f32 v143, v143, v159
    v_add_f32 v160, v160, v176
    v_add_f32 v161, v161, v177
    v_add_f32 v162, v162, v178
    v_add_f32 v163, v163, v179
    v_add_f32 v164, v164, v180
    v_add_f32 v165, v165, v181
    v_add_f32 v166, v166, v182
    v_add_f32 v167, v167, v183
    v_add_f32 v168, v168, v184
    v_add_f32 v169, v169, v185
    v_add_f32 v170, v170, v186
    v_add_f32 v171, v171, v187
    v_add_f32 v172, v172, v188
    v_add_f32 v173, v173, v189
    v_add_f32 v174, v174, v190
    v_add_f32 v175, v175, v191
    v_add_f32 v128, v128, v160
    v_add_f32 v129, v129, v161
    v_add_f32 v130, v130, v162
    v_add_f32 v131, v131, v163
    v_add_f32 v132, v132, v164
    v_add_f32 v133, v133, v165
    v_add_f32 v134, v134, v166
    v_add_f32 v135, v135, v167
    v_add_f32 v136, v136, v168
    v_add_f32 v137, v137, v169
    v_add_f32 v138, v138, v170
    v_add_f32 v139, v139, v171
    v_add_f32 v140, v140, v172
    v_add_f32 v141, v141, v173
    v_add_f32 v142, v142, v174
    v_add_f32 v143, v143, v175
    v_add_f32 v192, v128, v192
    v_add_f32 v193, v129, v193
    v_add_f32 v194, v130, v194
    v_add_f32 v195, v131, v195
    v_add_f32 v196, v132, v196
    v_add_f32 v197, v133, v197
    v_add_f32 v198, v134, v198
    v_add_f32 v199, v135, v199
    v_add_f32 v200, v136, v200
    v_add_f32 v201, v137, v201
    v_add_f32 v202, v138, v202
    v_add_f32 v203, v139, v203
    v_add_f32 v204, v140, v204
    v_add_f32 v205, v141, v205
    v_add_f32 v206, v142, v206
    v_add_f32 v207, v143, v207
    v_mul_f32 v32, v192, v32
    v_mul_f32 v33, v193, v33
    v_mul_f32 v34, v194, v34
    v_mul_f32 v35, v195, v35
    v_mul_f32 v36, v196, v36
    v_mul_f32 v37, v197, v37
    v_mul_f32 v38, v198, v38
    v_mul_f32 v39, v199, v39
    v_mul_f32 v40, v200, v40
    v_mul_f32 v41, v201, v41
    v_mul_f32 v42, v202, v42
    v_mul_f32 v43, v203, v43
    v_mul_f32 v44, v204, v44
    v_mul_f32 v45, v205, v45
    v_mul_f32 v46, v206, v46
    v_mul_f32 v47, v207, v47
    v_add_f32 v32, v208, v32
    v_add_f32 v33, v209, v33
    v_add_f32 v34, v210, v34
    v_add_f32 v35, v211, v35
    v_add_f32 v36, v212, v36
    v_add_f32 v37, v213, v37
    v_add_f32 v38, v214, v38
    v_add_f32 v39, v215, v39
    v_add_f32 v40, v216, v40
    v_add_f32 v41, v217, v41
    v_add_f32 v42, v218, v42
    v_add_f32 v43, v219, v43
    v_add_f32 v44, v220, v44
    v_add_f32 v45, v221, v45
    v_add_f32 v46, v222, v46
    v_add_f32 v47, v223, v47
    buffer_store_dwordx4 v[32:35], v11, s[32:35], 0 offen offset:0
    buffer_store_dwordx4 v[36:39], v11, s[32:35], 0 offen offset:64
    buffer_store_dwordx4 v[40:43], v11, s[32:35], 0 offen offset:128
    buffer_store_dwordx4 v[44:47], v11, s[32:35], 0 offen offset:192
K2_END:
    s_endpgm

.section .rodata,"a"
.p2align 6
.amdhsa_kernel ssm_k0_kernel
  .amdhsa_next_free_vgpr 72
  .amdhsa_next_free_sgpr 102
  .amdhsa_accum_offset 72
  .amdhsa_group_segment_fixed_size 0
  .amdhsa_kernarg_size 128
  .amdhsa_user_sgpr_count 2
  .amdhsa_user_sgpr_kernarg_segment_ptr 1
  .amdhsa_system_sgpr_workgroup_id_x 1
  .amdhsa_float_denorm_mode_32 3
  .amdhsa_float_denorm_mode_16_64 3
.end_amdhsa_kernel

.p2align 6
.amdhsa_kernel ssm_k1_kernel
  .amdhsa_next_free_vgpr 256
  .amdhsa_next_free_sgpr 102
  .amdhsa_accum_offset 96
  .amdhsa_group_segment_fixed_size 0
  .amdhsa_kernarg_size 128
  .amdhsa_user_sgpr_count 2
  .amdhsa_user_sgpr_kernarg_segment_ptr 1
  .amdhsa_system_sgpr_workgroup_id_x 1
  .amdhsa_float_denorm_mode_32 3
  .amdhsa_float_denorm_mode_16_64 3
.end_amdhsa_kernel

.p2align 6
.amdhsa_kernel ssm_k2_kernel
  .amdhsa_next_free_vgpr 512
  .amdhsa_next_free_sgpr 102
  .amdhsa_accum_offset 256
  .amdhsa_group_segment_fixed_size 0
  .amdhsa_kernarg_size 128
  .amdhsa_user_sgpr_count 2
  .amdhsa_user_sgpr_kernarg_segment_ptr 1
  .amdhsa_system_sgpr_workgroup_id_x 1
  .amdhsa_float_denorm_mode_32 3
  .amdhsa_float_denorm_mode_16_64 3
.end_amdhsa_kernel
```
